```python
import torch

def _softmax(x, axis=-1):
    return torch.softmax(x, dim=axis)
def _gelu(x):
    return torch.nn.functional.gelu(x, approximate="tanh")
def _silu(x):
    return torch.nn.functional.silu(x)
def _sigmoid(x):
    return torch.sigmoid(x)
def _layernorm(x, axis=-1, eps=1e-5):
    m = x.mean(dim=axis, keepdim=True)
    v = x.var(dim=axis, keepdim=True, unbiased=False)
    return (x - m) / torch.sqrt(v + eps)
def _scatter_add(tgt, idx, src, axis=0):
    return tgt.clone().index_add_(axis, idx, src)
def _segment_sum(src, seg, n):
    out = torch.zeros((n,) + src.shape[1:], dtype=src.dtype)
    return out.index_add_(0, seg, src)
def _pad(x, pw):
    flat = tuple(v for pair in reversed(pw) for v in pair)
    return torch.nn.functional.pad(x, flat)

kernel_name = 'parallel_sum__gqa_block_cached__glu_gated_swiglu__decode'

def setup_inputs():

    _w = (lambda a: (lambda t: t.to(torch.bfloat16) if t.is_floating_point() else t)(torch.as_tensor(a)))
    def _A_setup():
        B, Sq, D = 4, 1, 512
        Hq, Hkv, Sk, Dh = 32, 8, 4096, 128
        assert Hq % Hkv == 0, (Hq, Hkv)
        return {
            "x": _w((lambda *s: torch.randn(*s, dtype=torch.bfloat16) * 0.05)(B, Sq, D)),
            "k_cache": _w((lambda *s: torch.randn(*s, dtype=torch.bfloat16) * 1.6)(B, Hkv, Sk, Dh)),
            "v_cache": _w((lambda *s: torch.randn(*s, dtype=torch.bfloat16) * 0.8)(B, Hkv, Sk, Dh)),
            "wq": _w((lambda *s: torch.randn(*s, dtype=torch.bfloat16) * 1.6)(D, Hq * Dh) * (D ** -0.5)),
            "wo": _w((lambda *s: torch.randn(*s, dtype=torch.bfloat16) * 0.8)(Hq * Dh, D) * ((Hq * Dh) ** -0.5)),
        }
    _A_in = _A_setup()

    def _B_setup():
        B, S, D, F = 4, 1, 512, 1792
        return {
            "x": _w((lambda *s: torch.randn(*s, dtype=torch.bfloat16) * 0.05)(B, S, D)),
            "w1": _w((lambda *s: torch.randn(*s, dtype=torch.bfloat16) * 0.4)(D, F) * (2.0 / D) ** 0.5),
            "w3": _w((lambda *s: torch.randn(*s, dtype=torch.bfloat16) * 0.4)(D, F) * (2.0 / D) ** 0.5),
            "w2": _w((lambda *s: torch.randn(*s, dtype=torch.bfloat16) * 0.4)(F, D) * (2.0 / F) ** 0.5),
        }
    _B_in = _B_setup()

    return {
        "A_x": _A_in["x"],
        "A_k_cache": _A_in["k_cache"],
        "A_v_cache": _A_in["v_cache"],
        "A_wq": _A_in["wq"],
        "A_wo": _A_in["wo"],
        "B_x": _B_in["x"],
        "B_w1": _B_in["w1"],
        "B_w3": _B_in["w3"],
        "B_w2": _B_in["w2"],
    }

def reference(A_x, A_k_cache, A_v_cache, A_wq, A_wo, B_x, B_w1, B_w3, B_w2):
    def _A_ref(x, k_cache, v_cache, wq, wo):
        B, Sq, D = x.shape
        Hq, Dh = 32, 128
        Hkv = k_cache.shape[1]
        rep = Hq // Hkv
        q = (lambda x, *d: x.permute(*d))((x @ wq).reshape(B, Sq, Hq, Dh), 0, 2, 1, 3)
        k = (lambda x, n, axis: torch.repeat_interleave(x, n, dim=axis))(k_cache, rep, axis=1)
        v = (lambda x, n, axis: torch.repeat_interleave(x, n, dim=axis))(v_cache, rep, axis=1)
        scores = torch.einsum("bhqd,bhkd->bhqk", q, k) * (Dh ** -0.5)
        p = _softmax(scores, axis=-1)
        o = torch.einsum("bhqk,bhkd->bhqd", p, v)
        return (lambda x, *d: x.permute(*d))(o, 0, 2, 1, 3).reshape(B, Sq, Hq * Dh) @ wo

    def _B_ref(x, w1, w3, w2):
        gate = torch.einsum("bsd,df->bsf", x, w1)
        up = torch.einsum("bsd,df->bsf", x, w3)
        h = _silu(gate) * up
        out = torch.einsum("bsf,fd->bsd", h, w2)
        return out

    x = A_x
    xn = _layernorm(x, axis=-1)
    return x + _A_ref(xn, A_k_cache, A_v_cache, A_wq, A_wo) + _B_ref(xn, B_w1, B_w3, B_w2)
```

```asm
; @launch grid=(256,1,1) block=(768,1,1) lds=158784
.amdgcn_target "amdgcn-amd-amdhsa--gfx950"
.text
.globl parallel_sum__gqa_block_cached__glu_gated_swiglu__decode_kernel
.p2align 8
.type parallel_sum__gqa_block_cached__glu_gated_swiglu__decode_kernel,@function
parallel_sum__gqa_block_cached__glu_gated_swiglu__decode_kernel:
  s_cmp_ge_u32 s2, 256
  s_cbranch_scc1 L_end
  s_load_dwordx16 s[16:31], s[0:1], 0
  s_load_dwordx8 s[32:39], s[0:1], 64
  v_lshrrev_b32 v1, 6, v0
  v_and_b32 v0, 63, v0
  v_readfirstlane_b32 s3, v1
  s_add_u32 s4, s2, 0
  s_and_b32 s4, s4, 7
  s_lshr_b32 s5, s2, 3
  s_lshr_b32 s6, s5, 3
  s_and_b32 s7, s5, 7
  s_lshl_b32 s9, s4, 5
  s_add_u32 s9, s9, s5
  s_mul_i32 s10, s4, 28
  s_add_u32 s10, s10, s5
  v_and_b32 v1, 15, v0
  v_lshrrev_b32 v2, 4, v0
  s_mov_b32 s60, 0x05040100
  s_mov_b32 s61, 0x07060302
  s_mov_b32 s62, 0xffff0000
  s_mov_b32 s8, s3
  s_mov_b32 s42, 0x2000000
  s_mov_b32 s43, 0x20000
  s_lshl_b32 s64, s6, 3
  s_add_u32 s64, s64, s4
  s_lshl_b32 s64, s64, 20
  s_lshl_b32 s70, s7, 17
  s_add_u32 s64, s64, s70
  s_lshl_b32 s70, s8, 10
  s_add_u32 s64, s64, s70
  s_mov_b32 s65, s64
  s_lshl_b32 s66, s8, 14
  v_lshlrev_b32 v3, 2, v2
  v_xor_b32 v3, v3, v1
  v_xor_b32 v4, 0, v3
  v_lshlrev_b32 v4, 4, v4
  v_lshl_add_u32 v4, v2, 8, v4
  v_xor_b32 v5, 1, v3
  v_lshlrev_b32 v5, 4, v5
  v_lshl_add_u32 v5, v2, 8, v5
  v_xor_b32 v6, 2, v3
  v_lshlrev_b32 v6, 4, v6
  v_lshl_add_u32 v6, v2, 8, v6
  v_xor_b32 v7, 3, v3
  v_lshlrev_b32 v7, 4, v7
  v_lshl_add_u32 v7, v2, 8, v7
  v_lshlrev_b32 v8, 4, v0
  s_mov_b32 m0, s66
  s_sub_u32 s3, s3, 8
  s_waitcnt lgkmcnt(0)
  s_cbranch_scc0 L_service
  s_mov_b32 s40, s18
  s_and_b32 s41, s19, 0xffff
  buffer_load_dwordx4 v4, s[40:43], s64 offen nt lds
  s_barrier
  s_load_dwordx2 s[58:59], s[38:39], 0
  s_mov_b32 s48, s38
  s_and_b32 s49, s39, 0xffff
  s_mov_b32 s50, 6291456
  s_mov_b32 s51, 0x20000
  s_mov_b32 s44, s20
  s_and_b32 s45, s21, 0xffff
  s_mov_b32 s46, 33554432
  s_mov_b32 s47, 0x20000
  s_mov_b32 s52, s24
  s_and_b32 s53, s25, 0xffff
  s_mov_b32 s54, 4194304
  s_mov_b32 s55, 0x20000
  s_mov_b32 s12, s32
  s_and_b32 s13, s33, 0xffff
  s_mov_b32 s14, 1835008
  s_mov_b32 s15, 0x20000
  s_lshl_b32 s68, s4, 2
  s_add_u32 s68, s68, s6
  s_lshl_b32 s67, s68, 7
  s_lshr_b32 s70, s8, 2
  s_lshl_b32 s70, s70, 5
  s_add_u32 s67, s67, s70
  s_and_b32 s70, s8, 3
  s_lshl_b32 s70, s70, 1
  s_add_u32 s67, s67, s70
  s_lshl_b32 s67, s67, 10
  s_lshl_b32 s70, s7, 7
  s_add_u32 s67, s67, s70
  s_mul_i32 s69, s68, 128
  s_mul_i32 s68, s68, 56
  s_lshl_b32 s71, s8, 3
  s_add_u32 s68, s68, s71
  s_lshl_b32 s68, s68, 10
  s_add_u32 s68, s68, s70
  s_cmp_eq_u32 s8, 7
  s_cselect_b32 s68, 0x40000000, s68
  v_lshrrev_b32 v9, 3, v0
  v_bfe_u32 v10, v9, 1, 1
  s_and_b32 s70, s8, 1
  s_lshl_b32 s70, s70, 1
  v_or_b32 v10, s70, v10
  v_lshlrev_b32 v10, 1, v10
  v_and_b32 v3, 7, v0
  v_xor_b32 v10, v10, v3
  v_lshlrev_b32 v10, 4, v10
  v_lshl_add_u32 v82, v9, 10, v10
  v_and_b32 v3, 3, v9
  v_lshrrev_b32 v9, 2, v9
  v_lshl_add_u32 v9, v3, 3, v9
  v_lshl_add_u32 v80, v9, 10, v10
  v_lshrrev_b32 v9, 2, v1
  v_lshl_add_u32 v10, v2, 3, v9
  v_lshlrev_b32 v84, 7, v10
  v_lshrrev_b32 v9, 1, v9
  v_and_b32 v10, 1, v2
  v_lshl_add_u32 v9, v10, 1, v9
  s_and_b32 s70, s8, 3
  v_xor_b32 v9, s70, v9
  v_lshl_add_u32 v84, v9, 5, v84
  v_and_b32 v9, 3, v1
  v_lshl_add_u32 v84, v9, 3, v84
  v_add_u32 v84, 134208, v84
  v_and_b32 v3, 3, v1
  v_lshrrev_b32 v11, 2, v1
  v_lshl_add_u32 v3, v3, 2, v11
  v_lshlrev_b32 v3, 8, v3
  s_lshl_b32 s73, s8, 14
  v_add_u32 v3, s73, v3
  v_xor_b32 v11, v2, v1
  v_xor_b32 v12, 0, v11
  v_lshl_add_u32 v12, v12, 4, v3
  v_xor_b32 v13, 4, v11
  v_lshl_add_u32 v13, v13, 4, v3
  v_xor_b32 v14, 8, v11
  v_lshl_add_u32 v14, v14, 4, v3
  v_xor_b32 v15, 12, v11
  v_lshl_add_u32 v15, v15, 4, v3
  v_and_b32 v11, 3, v0
  v_lshlrev_b32 v160, 8, v11
  v_lshl_add_u32 v160, v2, 4, v160
  v_add_u32 v160, 131072, v160
  v_mul_u32_u24 v161, 384, v11
  v_lshl_add_u32 v161, v2, 4, v161
  v_add_u32 v161, 132096, v161
  v_lshl_add_u32 v162, v2, 4, s73
  v_xor_b32 v3, 0, v11
  v_lshl_add_u32 v85, v3, 6, v162
  v_xor_b32 v3, 1, v11
  v_lshl_add_u32 v86, v3, 6, v162
  v_xor_b32 v3, 2, v11
  v_lshl_add_u32 v87, v3, 6, v162
  v_xor_b32 v3, 3, v11
  v_lshl_add_u32 v88, v3, 6, v162
  v_lshlrev_b32 v163, 3, v1
  v_add_u32 v163, s73, v163
  s_movk_i32 s70, 8704
  v_mul_u32_u24 v164, s70, v11
  v_lshl_add_u32 v164, v2, 4, v164
  s_lshl_b32 s70, s7, 3
  s_bfe_u32 s71, s8, 0x10001
  s_add_u32 s70, s70, s71
  s_mul_i32 s70, s70, 4352
  s_add_u32 s69, s69, s70
  s_and_b32 s70, s8, 1
  s_lshl_b32 s70, s70, 6
  s_add_u32 s69, s69, s70
  s_add_u32 s69, s69, 1376256
  s_mov_b32 s71, 1035273459
  s_mov_b32 s72, 1069066811
  v_cmp_gt_u32 s[74:75], 4, v1
  s_waitcnt lgkmcnt(0)
  s_add_u32 s58, s58, 1
  s_addc_u32 s59, s59, 0
  s_add_u32 s64, s64, 8192
  s_add_u32 s66, s66, 1024
  s_mov_b32 m0, s66
  s_nop 0
  buffer_load_dwordx4 v5, s[40:43], s64 offen nt lds
  s_waitcnt vmcnt(1)
  s_add_u32 s64, s64, 8192
  s_add_u32 s66, s66, 1024
  s_mov_b32 m0, s66
  s_nop 0
  buffer_load_dwordx4 v6, s[40:43], s64 offen nt lds
  s_waitcnt vmcnt(1)
  s_add_u32 s64, s64, 8192
  s_add_u32 s66, s66, 1024
  s_mov_b32 m0, s66
  s_nop 0
  buffer_load_dwordx4 v7, s[40:43], s64 offen nt lds
  s_waitcnt vmcnt(1)
  s_add_u32 s64, s64, 8192
  s_add_u32 s66, s66, 1024
  s_mov_b32 m0, s66
  s_nop 0
  buffer_load_dwordx4 v4, s[40:43], s64 offen nt lds
  s_waitcnt vmcnt(1)
  s_add_u32 s64, s64, 8192
  s_add_u32 s66, s66, 1024
  s_mov_b32 m0, s66
  s_nop 0
  buffer_load_dwordx4 v5, s[40:43], s64 offen nt lds
  s_waitcnt vmcnt(1)
  s_add_u32 s64, s64, 8192
  s_add_u32 s66, s66, 1024
  s_mov_b32 m0, s66
  s_nop 0
  buffer_load_dwordx4 v6, s[40:43], s64 offen nt lds
  s_add_u32 s64, s64, 8192
  s_add_u32 s66, s66, 1024
  s_mov_b32 m0, s66
  s_nop 0
  buffer_load_dwordx4 v7, s[40:43], s64 offen nt lds
  s_add_u32 s64, s64, 8192
  s_add_u32 s66, s66, 1024
  s_mov_b32 m0, s66
  s_nop 0
  buffer_load_dwordx4 v4, s[40:43], s64 offen nt lds
  s_waitcnt vmcnt(3)
  s_add_u32 s64, s64, 8192
  s_add_u32 s66, s66, 1024
  s_mov_b32 m0, s66
  s_nop 0
  buffer_load_dwordx4 v5, s[40:43], s64 offen nt lds
  s_waitcnt vmcnt(3)
  s_add_u32 s64, s64, 8192
  s_add_u32 s66, s66, 1024
  s_mov_b32 m0, s66
  s_nop 0
  buffer_load_dwordx4 v6, s[40:43], s64 offen nt lds
  s_waitcnt vmcnt(3)
  s_add_u32 s64, s64, 8192
  s_add_u32 s66, s66, 1024
  s_mov_b32 m0, s66
  s_nop 0
  buffer_load_dwordx4 v7, s[40:43], s64 offen nt lds
  s_waitcnt vmcnt(3)
  s_add_u32 s64, s64, 8192
  s_add_u32 s66, s66, 1024
  s_mov_b32 m0, s66
  s_nop 0
  buffer_load_dwordx4 v4, s[40:43], s64 offen nt lds
  s_waitcnt vmcnt(3)
  s_add_u32 s64, s64, 8192
  s_add_u32 s66, s66, 1024
  s_mov_b32 m0, s66
  s_nop 0
  buffer_load_dwordx4 v5, s[40:43], s64 offen nt lds
  s_waitcnt vmcnt(3)
  s_add_u32 s64, s64, 8192
  s_add_u32 s66, s66, 1024
  s_mov_b32 m0, s66
  s_nop 0
  buffer_load_dwordx4 v6, s[40:43], s64 offen nt lds
  s_waitcnt vmcnt(3)
  s_add_u32 s64, s64, 8192
  s_add_u32 s66, s66, 1024
  s_mov_b32 m0, s66
  s_nop 0
  buffer_load_dwordx4 v7, s[40:43], s64 offen nt lds
  s_waitcnt vmcnt(3)
  buffer_load_dwordx4 v[16:19], v8, s[44:47], s65 offen nt
  s_waitcnt vmcnt(3)
  s_add_u32 s65, s65, 8192
  buffer_load_dwordx4 v[20:23], v8, s[44:47], s65 offen nt
  s_waitcnt vmcnt(3)
  s_add_u32 s65, s65, 8192
  buffer_load_dwordx4 v[24:27], v8, s[44:47], s65 offen nt
  s_waitcnt vmcnt(3)
  s_add_u32 s65, s65, 8192
  buffer_load_dwordx4 v[28:31], v8, s[44:47], s65 offen nt
  s_waitcnt vmcnt(3)
  s_add_u32 s65, s65, 8192
  buffer_load_dwordx4 v[32:35], v8, s[44:47], s65 offen nt
  s_barrier
  ds_read_b128 v[128:131], v160 offset:0
  ds_read_b128 v[132:135], v160 offset:64
  ds_read_b128 v[136:139], v160 offset:128
  ds_read_b128 v[140:143], v160 offset:192
  ds_read_b128 v[96:99], v12 offset:0
  ds_read_b128 v[100:103], v13 offset:0
  ds_read_b128 v[104:107], v14 offset:0
  ds_read_b128 v[108:111], v15 offset:0
  ds_read_b128 v[112:115], v12 offset:4096
  ds_read_b128 v[116:119], v13 offset:4096
  ds_read_b128 v[120:123], v14 offset:4096
  ds_read_b128 v[124:127], v15 offset:4096
  s_waitcnt lgkmcnt(7)
  v_mfma_f32_16x16x32_bf16 v[144:147], v[96:99], v[128:131], 0
  s_waitcnt lgkmcnt(6)
  v_mfma_f32_16x16x32_bf16 v[144:147], v[100:103], v[132:135], v[144:147]
  s_waitcnt lgkmcnt(5)
  v_mfma_f32_16x16x32_bf16 v[144:147], v[104:107], v[136:139], v[144:147]
  s_waitcnt lgkmcnt(4)
  v_mfma_f32_16x16x32_bf16 v[144:147], v[108:111], v[140:143], v[144:147]
  s_waitcnt lgkmcnt(3)
  v_mfma_f32_16x16x32_bf16 v[148:151], v[112:115], v[128:131], 0
  s_waitcnt lgkmcnt(2)
  v_mfma_f32_16x16x32_bf16 v[148:151], v[116:119], v[132:135], v[148:151]
  s_waitcnt lgkmcnt(1)
  v_mfma_f32_16x16x32_bf16 v[148:151], v[120:123], v[136:139], v[148:151]
  s_waitcnt lgkmcnt(0)
  v_mfma_f32_16x16x32_bf16 v[148:151], v[124:127], v[140:143], v[148:151]
  s_waitcnt vmcnt(3)
  s_add_u32 s65, s65, 8192
  buffer_load_dwordx4 v[36:39], v8, s[44:47], s65 offen nt
  ds_read_b128 v[96:99], v12 offset:8192
  ds_read_b128 v[100:103], v13 offset:8192
  ds_read_b128 v[104:107], v14 offset:8192
  ds_read_b128 v[108:111], v15 offset:8192
  ds_read_b128 v[112:115], v12 offset:12288
  ds_read_b128 v[116:119], v13 offset:12288
  ds_read_b128 v[120:123], v14 offset:12288
  ds_read_b128 v[124:127], v15 offset:12288
  s_waitcnt lgkmcnt(7)
  v_mfma_f32_16x16x32_bf16 v[152:155], v[96:99], v[128:131], 0
  s_waitcnt lgkmcnt(6)
  v_mfma_f32_16x16x32_bf16 v[152:155], v[100:103], v[132:135], v[152:155]
  s_waitcnt lgkmcnt(5)
  v_mfma_f32_16x16x32_bf16 v[152:155], v[104:107], v[136:139], v[152:155]
  s_waitcnt lgkmcnt(4)
  v_mfma_f32_16x16x32_bf16 v[152:155], v[108:111], v[140:143], v[152:155]
  s_waitcnt lgkmcnt(3)
  v_mfma_f32_16x16x32_bf16 v[156:159], v[112:115], v[128:131], 0
  s_waitcnt lgkmcnt(2)
  v_mfma_f32_16x16x32_bf16 v[156:159], v[116:119], v[132:135], v[156:159]
  s_waitcnt lgkmcnt(1)
  v_mfma_f32_16x16x32_bf16 v[156:159], v[120:123], v[136:139], v[156:159]
  s_waitcnt lgkmcnt(0)
  v_mfma_f32_16x16x32_bf16 v[156:159], v[124:127], v[140:143], v[156:159]
  s_waitcnt vmcnt(3)
  s_add_u32 s65, s65, 8192
  buffer_load_dwordx4 v[40:43], v8, s[44:47], s65 offen nt
  v_cvt_pk_bf16_f32 v165, v144, v145
  v_lshlrev_b32 v144, 16, v165
  v_and_b32 v145, s62, v165
  v_cvt_pk_bf16_f32 v165, v146, v147
  v_lshlrev_b32 v146, 16, v165
  v_and_b32 v147, s62, v165
  v_cvt_pk_bf16_f32 v165, v148, v149
  v_lshlrev_b32 v148, 16, v165
  v_and_b32 v149, s62, v165
  v_cvt_pk_bf16_f32 v165, v150, v151
  v_lshlrev_b32 v150, 16, v165
  v_and_b32 v151, s62, v165
  v_cvt_pk_bf16_f32 v165, v152, v153
  v_lshlrev_b32 v152, 16, v165
  v_and_b32 v153, s62, v165
  v_cvt_pk_bf16_f32 v165, v154, v155
  v_lshlrev_b32 v154, 16, v165
  v_and_b32 v155, s62, v165
  v_cvt_pk_bf16_f32 v165, v156, v157
  v_lshlrev_b32 v156, 16, v165
  v_and_b32 v157, s62, v165
  v_cvt_pk_bf16_f32 v165, v158, v159
  v_lshlrev_b32 v158, 16, v165
  v_and_b32 v159, s62, v165
  v_mul_f32 v144, s71, v144
  v_mul_f32 v145, s71, v145
  v_mul_f32 v146, s71, v146
  v_mul_f32 v147, s71, v147
  v_mul_f32 v148, s71, v148
  v_mul_f32 v149, s71, v149
  v_mul_f32 v150, s71, v150
  v_mul_f32 v151, s71, v151
  v_mul_f32 v152, s71, v152
  v_mul_f32 v153, s71, v153
  v_mul_f32 v154, s71, v154
  v_mul_f32 v155, s71, v155
  v_mul_f32 v156, s71, v156
  v_mul_f32 v157, s71, v157
  v_mul_f32 v158, s71, v158
  v_mul_f32 v159, s71, v159
  v_cvt_pk_bf16_f32 v165, v144, v145
  v_lshlrev_b32 v144, 16, v165
  v_and_b32 v145, s62, v165
  v_cvt_pk_bf16_f32 v165, v146, v147
  v_lshlrev_b32 v146, 16, v165
  v_and_b32 v147, s62, v165
  v_cvt_pk_bf16_f32 v165, v148, v149
  v_lshlrev_b32 v148, 16, v165
  v_and_b32 v149, s62, v165
  v_cvt_pk_bf16_f32 v165, v150, v151
  v_lshlrev_b32 v150, 16, v165
  v_and_b32 v151, s62, v165
  v_cvt_pk_bf16_f32 v165, v152, v153
  v_lshlrev_b32 v152, 16, v165
  v_and_b32 v153, s62, v165
  v_cvt_pk_bf16_f32 v165, v154, v155
  v_lshlrev_b32 v154, 16, v165
  v_and_b32 v155, s62, v165
  v_cvt_pk_bf16_f32 v165, v156, v157
  v_lshlrev_b32 v156, 16, v165
  v_and_b32 v157, s62, v165
  v_cvt_pk_bf16_f32 v165, v158, v159
  v_lshlrev_b32 v158, 16, v165
  v_and_b32 v159, s62, v165
  v_max3_f32 v166, v144, v145, v146
  v_max3_f32 v167, v147, v148, v149
  v_max3_f32 v167, v167, v150, v151
  v_max3_f32 v166, v166, v152, v153
  v_max3_f32 v167, v167, v154, v155
  v_max3_f32 v166, v166, v156, v157
  v_max3_f32 v167, v167, v158, v159
  v_max_f32 v166, v166, v167
  v_mov_b32 v167, v166
  s_nop 1
  v_permlane32_swap_b32 v166, v167
  v_max_f32 v166, v166, v167
  v_mov_b32 v167, v166
  s_nop 1
  v_permlane16_swap_b32 v166, v167
  v_max_f32 v166, v166, v167
  v_mul_f32 v166, s72, v166
  s_waitcnt vmcnt(3)
  s_add_u32 s65, s65, 8192
  buffer_load_dwordx4 v[44:47], v8, s[44:47], s65 offen nt
  v_fma_f32 v144, v144, s72, -v166
  v_fma_f32 v145, v145, s72, -v166
  v_fma_f32 v146, v146, s72, -v166
  v_fma_f32 v147, v147, s72, -v166
  v_fma_f32 v148, v148, s72, -v166
  v_fma_f32 v149, v149, s72, -v166
  v_fma_f32 v150, v150, s72, -v166
  v_fma_f32 v151, v151, s72, -v166
  v_fma_f32 v152, v152, s72, -v166
  v_fma_f32 v153, v153, s72, -v166
  v_fma_f32 v154, v154, s72, -v166
  v_fma_f32 v155, v155, s72, -v166
  v_fma_f32 v156, v156, s72, -v166
  v_fma_f32 v157, v157, s72, -v166
  v_fma_f32 v158, v158, s72, -v166
  v_fma_f32 v159, v159, s72, -v166
  v_exp_f32 v144, v144
  v_exp_f32 v145, v145
  v_exp_f32 v146, v146
  v_exp_f32 v147, v147
  v_exp_f32 v148, v148
  v_exp_f32 v149, v149
  v_exp_f32 v150, v150
  v_exp_f32 v151, v151
  v_exp_f32 v152, v152
  v_exp_f32 v153, v153
  v_exp_f32 v154, v154
  v_exp_f32 v155, v155
  v_exp_f32 v156, v156
  v_exp_f32 v157, v157
  v_exp_f32 v158, v158
  v_exp_f32 v159, v159
  v_add_f32 v167, v144, v145
  v_add_f32 v165, v146, v147
  v_add_f32 v167, v167, v148
  v_add_f32 v165, v165, v149
  v_add_f32 v167, v167, v150
  v_add_f32 v165, v165, v151
  v_add_f32 v167, v167, v152
  v_add_f32 v165, v165, v153
  v_add_f32 v167, v167, v154
  v_add_f32 v165, v165, v155
  v_add_f32 v167, v167, v156
  v_add_f32 v165, v165, v157
  v_add_f32 v167, v167, v158
  v_add_f32 v165, v165, v159
  v_add_f32 v167, v167, v165
  v_mov_b32 v165, v167
  s_nop 1
  v_permlane32_swap_b32 v167, v165
  v_add_f32 v167, v167, v165
  v_mov_b32 v165, v167
  s_nop 1
  v_permlane16_swap_b32 v167, v165
  v_add_f32 v167, v167, v165
  v_cvt_pk_bf16_f32 v144, v144, v145
  v_cvt_pk_bf16_f32 v145, v146, v147
  v_cvt_pk_bf16_f32 v146, v148, v149
  v_cvt_pk_bf16_f32 v147, v150, v151
  v_cvt_pk_bf16_f32 v148, v152, v153
  v_cvt_pk_bf16_f32 v149, v154, v155
  v_cvt_pk_bf16_f32 v150, v156, v157
  v_cvt_pk_bf16_f32 v151, v158, v159
  s_mov_b64 exec, s[74:75]
  ds_write_b64 v163, v[166:167] offset:2048
  s_mov_b64 exec, -1
  s_waitcnt lgkmcnt(0)
  s_barrier
  s_waitcnt vmcnt(3)
  s_add_u32 s65, s65, 8192
  buffer_load_dwordx4 v[48:51], v8, s[44:47], s65 offen nt
  s_waitcnt vmcnt(3)
  s_add_u32 s65, s65, 8192
  buffer_load_dwordx4 v[52:55], v8, s[44:47], s65 offen nt
  s_waitcnt vmcnt(3)
  s_add_u32 s65, s65, 8192
  buffer_load_dwordx4 v[56:59], v8, s[44:47], s65 offen nt
  s_waitcnt vmcnt(3)
  s_add_u32 s65, s65, 8192
  buffer_load_dwordx4 v[60:63], v8, s[44:47], s65 offen nt
  v_perm_b32 v128, v20, v16, s60
  v_perm_b32 v129, v28, v24, s60
  v_perm_b32 v130, v36, v32, s60
  v_perm_b32 v131, v44, v40, s60
  v_perm_b32 v132, v20, v16, s61
  v_perm_b32 v133, v28, v24, s61
  v_perm_b32 v134, v36, v32, s61
  v_perm_b32 v135, v44, v40, s61
  v_mfma_f32_16x16x32_bf16 v[96:99], v[128:131], v[144:147], 0
  v_perm_b32 v136, v21, v17, s60
  v_perm_b32 v137, v29, v25, s60
  v_perm_b32 v138, v37, v33, s60
  v_perm_b32 v139, v45, v41, s60
  v_mfma_f32_16x16x32_bf16 v[100:103], v[132:135], v[144:147], 0
  v_perm_b32 v128, v21, v17, s61
  v_perm_b32 v129, v29, v25, s61
  v_perm_b32 v130, v37, v33, s61
  v_perm_b32 v131, v45, v41, s61
  v_mfma_f32_16x16x32_bf16 v[104:107], v[136:139], v[144:147], 0
  v_perm_b32 v132, v22, v18, s60
  v_perm_b32 v133, v30, v26, s60
  v_perm_b32 v134, v38, v34, s60
  v_perm_b32 v135, v46, v42, s60
  v_mfma_f32_16x16x32_bf16 v[108:111], v[128:131], v[144:147], 0
  v_perm_b32 v136, v22, v18, s61
  v_perm_b32 v137, v30, v26, s61
  v_perm_b32 v138, v38, v34, s61
  v_perm_b32 v139, v46, v42, s61
  v_mfma_f32_16x16x32_bf16 v[112:115], v[132:135], v[144:147], 0
  v_perm_b32 v128, v23, v19, s60
  v_perm_b32 v129, v31, v27, s60
  v_perm_b32 v130, v39, v35, s60
  v_perm_b32 v131, v47, v43, s60
  v_mfma_f32_16x16x32_bf16 v[116:119], v[136:139], v[144:147], 0
  v_perm_b32 v132, v23, v19, s61
  v_perm_b32 v133, v31, v27, s61
  v_perm_b32 v134, v39, v35, s61
  v_perm_b32 v135, v47, v43, s61
  v_mfma_f32_16x16x32_bf16 v[120:123], v[128:131], v[144:147], 0
  s_nop 0
  v_mfma_f32_16x16x32_bf16 v[124:127], v[132:135], v[144:147], 0
  s_waitcnt vmcnt(3)
  s_add_u32 s65, s65, 8192
  buffer_load_dwordx4 v[64:67], v8, s[44:47], s65 offen nt
  s_waitcnt vmcnt(3)
  s_add_u32 s65, s65, 8192
  buffer_load_dwordx4 v[68:71], v8, s[44:47], s65 offen nt
  s_waitcnt vmcnt(3)
  s_add_u32 s65, s65, 8192
  buffer_load_dwordx4 v[72:75], v8, s[44:47], s65 offen nt
  s_waitcnt vmcnt(3)
  s_add_u32 s65, s65, 8192
  buffer_load_dwordx4 v[76:79], v8, s[44:47], s65 offen nt
  s_waitcnt vmcnt(3)
  s_lshl_b32 s70, s8, 10
  s_add_u32 s70, s70, 134208
  s_mov_b32 m0, s70
  s_add_u32 s11, s67, 65536
  buffer_load_dwordx4 v80, s[52:55], s67 offen nt lds
  s_waitcnt vmcnt(3)
  s_add_u32 s70, s70, 8192
  s_mov_b32 m0, s70
  s_nop 0
  buffer_load_dwordx4 v80, s[52:55], s11 offen nt lds
  s_waitcnt vmcnt(3)
  s_add_u32 s70, s70, 8192
  s_mov_b32 m0, s70
  s_nop 0
  buffer_load_dwordx4 v82, s[12:15], s68 offen nt lds
  s_waitcnt vmcnt(3)
  v_perm_b32 v128, v52, v48, s60
  v_perm_b32 v129, v60, v56, s60
  v_perm_b32 v130, v68, v64, s60
  v_perm_b32 v131, v76, v72, s60
  v_perm_b32 v132, v52, v48, s61
  v_perm_b32 v133, v60, v56, s61
  v_perm_b32 v134, v68, v64, s61
  v_perm_b32 v135, v76, v72, s61
  v_mfma_f32_16x16x32_bf16 v[96:99], v[128:131], v[148:151], v[96:99]
  v_perm_b32 v136, v53, v49, s60
  v_perm_b32 v137, v61, v57, s60
  v_perm_b32 v138, v69, v65, s60
  v_perm_b32 v139, v77, v73, s60
  v_mfma_f32_16x16x32_bf16 v[100:103], v[132:135], v[148:151], v[100:103]
  v_perm_b32 v128, v53, v49, s61
  v_perm_b32 v129, v61, v57, s61
  v_perm_b32 v130, v69, v65, s61
  v_perm_b32 v131, v77, v73, s61
  v_mfma_f32_16x16x32_bf16 v[104:107], v[136:139], v[148:151], v[104:107]
  v_perm_b32 v132, v54, v50, s60
  v_perm_b32 v133, v62, v58, s60
  v_perm_b32 v134, v70, v66, s60
  v_perm_b32 v135, v78, v74, s60
  v_mfma_f32_16x16x32_bf16 v[108:111], v[128:131], v[148:151], v[108:111]
  v_perm_b32 v136, v54, v50, s61
  v_perm_b32 v137, v62, v58, s61
  v_perm_b32 v138, v70, v66, s61
  v_perm_b32 v139, v78, v74, s61
  v_mfma_f32_16x16x32_bf16 v[112:115], v[132:135], v[148:151], v[112:115]
  v_perm_b32 v128, v55, v51, s60
  v_perm_b32 v129, v63, v59, s60
  v_perm_b32 v130, v71, v67, s60
  v_perm_b32 v131, v79, v75, s60
  v_mfma_f32_16x16x32_bf16 v[116:119], v[136:139], v[148:151], v[116:119]
  v_perm_b32 v132, v55, v51, s61
  v_perm_b32 v133, v63, v59, s61
  v_perm_b32 v134, v71, v67, s61
  v_perm_b32 v135, v79, v75, s61
  v_mfma_f32_16x16x32_bf16 v[120:123], v[128:131], v[148:151], v[120:123]
  s_nop 0
  v_mfma_f32_16x16x32_bf16 v[124:127], v[132:135], v[148:151], v[124:127]
  s_mov_b64 exec, s[74:75]
  ds_write_b128 v85, v[96:99] offset:0
  ds_write_b128 v86, v[100:103] offset:256
  ds_write_b128 v87, v[104:107] offset:512
  ds_write_b128 v88, v[108:111] offset:768
  ds_write_b128 v85, v[112:115] offset:1024
  ds_write_b128 v86, v[116:119] offset:1280
  ds_write_b128 v87, v[120:123] offset:1536
  ds_write_b128 v88, v[124:127] offset:1792
  s_mov_b64 exec, -1
  s_waitcnt lgkmcnt(0)
  s_barrier
  v_mov_b32 v18, s58
  v_mov_b32 v19, s59
  s_waitcnt vmcnt(0)
  s_barrier
  s_cmp_ge_u32 s8, 4
  s_cbranch_scc1 L_str_end
  ds_read_b64_tr_b16 v[24:25], v84 offset:0
  ds_read_b64_tr_b16 v[26:27], v84 offset:512
  ds_read_b128 v[48:51], v161 offset:0
  ds_read_b64_tr_b16 v[28:29], v84 offset:4096
  ds_read_b64_tr_b16 v[30:31], v84 offset:4608
  ds_read_b128 v[52:55], v161 offset:64
  ds_read_b64_tr_b16 v[32:33], v84 offset:8192
  ds_read_b64_tr_b16 v[34:35], v84 offset:8704
  ds_read_b128 v[56:59], v161 offset:128
  ds_read_b64_tr_b16 v[36:37], v84 offset:12288
  ds_read_b64_tr_b16 v[38:39], v84 offset:12800
  ds_read_b128 v[60:63], v161 offset:192
  ds_read_b64_tr_b16 v[40:41], v84 offset:16384
  ds_read_b64_tr_b16 v[42:43], v84 offset:16896
  ds_read_b128 v[64:67], v161 offset:256
  ds_read_b64_tr_b16 v[44:45], v84 offset:20480
  ds_read_b64_tr_b16 v[46:47], v84 offset:20992
  s_waitcnt lgkmcnt(14)
  v_mfma_f32_16x16x32_bf16 v[96:99], v[24:27], v[48:51], 0
  ds_read_b128 v[68:71], v161 offset:320
  s_waitcnt lgkmcnt(12)
  v_mfma_f32_16x16x32_bf16 v[100:103], v[28:31], v[52:55], 0
  s_waitcnt lgkmcnt(9)
  v_mfma_f32_16x16x32_bf16 v[96:99], v[32:35], v[56:59], v[96:99]
  s_waitcnt lgkmcnt(6)
  v_mfma_f32_16x16x32_bf16 v[100:103], v[36:39], v[60:63], v[100:103]
  s_waitcnt lgkmcnt(3)
  v_mfma_f32_16x16x32_bf16 v[96:99], v[40:43], v[64:67], v[96:99]
  s_waitcnt lgkmcnt(0)
  v_mfma_f32_16x16x32_bf16 v[100:103], v[44:47], v[68:71], v[100:103]
  s_nop 7
  v_add_f32 v96, v96, v100
  v_add_f32 v97, v97, v101
  v_add_f32 v98, v98, v102
  v_add_f32 v99, v99, v103
  v_cvt_pk_bf16_f32 v16, v96, v97
  v_cvt_pk_bf16_f32 v17, v98, v99
  s_mov_b64 exec, s[74:75]
  buffer_store_dwordx4 v[16:19], v164, s[48:51], s69 offen sc1
L_str_end:
L_end:
  s_endpgm
L_service:
  s_load_dwordx2 s[58:59], s[38:39], 0
  s_mov_b32 s48, s38
  s_and_b32 s49, s39, 0xffff
  s_mov_b32 s50, 6291456
  s_mov_b32 s51, 0x20000
  s_setprio 3
  s_mov_b32 s40, s16
  s_and_b32 s41, s17, 0xffff
  s_mov_b32 s42, 4096
  s_mov_b32 s43, 0x20000
  s_cmp_eq_u32 s3, 1
  s_cbranch_scc1 L_s1
  s_cmp_eq_u32 s3, 2
  s_cbranch_scc1 L_s2
  s_mov_b32 s14, s5
  s_mov_b32 s11, 138304
  s_cmp_eq_u32 s3, 3
  s_cbranch_scc1 L_s3
  s_cmp_ge_u32 s14, 30
  s_cbranch_scc1 L_s3
  s_mul_i32 s70, s4, 14
  s_add_u32 s70, s70, s14
  s_sub_u32 s70, s70, 16
  s_cmp_ge_u32 s14, 16
  s_cbranch_scc1 L_par_ffn
  s_mov_b32 s44, s22
  s_and_b32 s45, s23, 0xffff
  s_mov_b32 s46, 4194304
  s_mov_b32 s47, 0x20000
  s_mov_b32 s63, 8192
  s_and_b32 s68, s14, 1
  s_lshr_b32 s69, s14, 1
  s_lshl_b32 s64, s68, 21
  s_lshl_b32 s70, s4, 10
  s_add_u32 s64, s64, s70
  s_lshl_b32 s70, s69, 7
  s_add_u32 s64, s64, s70
  s_lshl_b32 s66, s4, 15
  s_lshl_b32 s70, s68, 12
  s_add_u32 s66, s66, s70
  s_lshl_b32 s70, s69, 9
  s_add_u32 s66, s66, s70
  s_add_u32 s66, s66, 65536
  v_and_b32 v6, 3, v1
  v_lshlrev_b32 v6, 13, v6
  v_and_b32 v7, 12, v1
  v_add_u32 v7, v7, v2
  v_lshl_add_u32 v6, v7, 4, v6
  v_add_u32 v7, 256, v6
  s_branch L_par_done
L_par_ffn:
  s_and_b32 s71, s70, 1
  s_bfe_u32 s68, s70, 0x10001
  s_lshr_b32 s69, s70, 2
  s_cmp_eq_u32 s71, 0
  s_cselect_b32 s44, s28, s30
  s_cselect_b32 s45, s29, s31
  s_and_b32 s45, s45, 0xffff
  s_mov_b32 s46, 1835008
  s_mov_b32 s47, 0x20000
  s_movk_i32 s63, 3584
  s_mul_i32 s64, s68, 917504
  s_lshl_b32 s70, s69, 7
  s_add_u32 s64, s64, s70
  s_lshl_b32 s71, s71, 1
  s_add_u32 s71, s71, s68
  s_mul_i32 s66, s71, 57344
  s_lshl_b32 s70, s69, 11
  s_add_u32 s66, s66, s70
  s_add_u32 s66, s66, 327680
  v_lshrrev_b32 v6, 2, v1
  v_lshrrev_b32 v7, 1, v2
  v_lshl_add_u32 v6, v6, 1, v7
  v_lshlrev_b32 v6, 8, v6
  v_and_b32 v7, 3, v1
  v_lshl_add_u32 v6, v7, 5, v6
  v_and_b32 v7, 1, v2
  v_lshl_add_u32 v6, v7, 4, v6
  v_add_u32 v7, 128, v6
L_par_done:
  v_lshrrev_b32 v5, 3, v0
  v_mul_lo_u32 v5, v5, s63
  v_and_b32 v8, 7, v0
  v_lshl_add_u32 v5, v8, 4, v5
  s_lshl_b32 s63, s63, 3
  buffer_load_dwordx4 v[40:43], v5, s[44:47], s64 offen nt
  s_add_u32 s64, s64, s63
  buffer_load_dwordx4 v[44:47], v5, s[44:47], s64 offen nt
  s_add_u32 s64, s64, s63
  buffer_load_dwordx4 v[48:51], v5, s[44:47], s64 offen nt
  s_add_u32 s64, s64, s63
  buffer_load_dwordx4 v[52:55], v5, s[44:47], s64 offen nt
  s_add_u32 s64, s64, s63
  s_barrier
  buffer_load_dwordx4 v[56:59], v5, s[44:47], s64 offen nt
  s_add_u32 s64, s64, s63
  buffer_load_dwordx4 v[60:63], v5, s[44:47], s64 offen nt
  s_add_u32 s64, s64, s63
  buffer_load_dwordx4 v[64:67], v5, s[44:47], s64 offen nt
  s_add_u32 s64, s64, s63
  buffer_load_dwordx4 v[68:71], v5, s[44:47], s64 offen nt
  s_add_u32 s64, s64, s63
  buffer_load_dwordx4 v[72:75], v5, s[44:47], s64 offen nt
  s_add_u32 s64, s64, s63
  buffer_load_dwordx4 v[76:79], v5, s[44:47], s64 offen nt
  s_add_u32 s64, s64, s63
  buffer_load_dwordx4 v[80:83], v5, s[44:47], s64 offen nt
  s_add_u32 s64, s64, s63
  buffer_load_dwordx4 v[84:87], v5, s[44:47], s64 offen nt
  s_add_u32 s64, s64, s63
  buffer_load_dwordx4 v[88:91], v5, s[44:47], s64 offen nt
  s_add_u32 s64, s64, s63
  buffer_load_dwordx4 v[92:95], v5, s[44:47], s64 offen nt
  s_add_u32 s64, s64, s63
  buffer_load_dwordx4 v[96:99], v5, s[44:47], s64 offen nt
  s_add_u32 s64, s64, s63
  buffer_load_dwordx4 v[100:103], v5, s[44:47], s64 offen nt
  s_add_u32 s64, s64, s63
  buffer_load_dwordx4 v[104:107], v5, s[44:47], s64 offen nt
  s_add_u32 s64, s64, s63
  buffer_load_dwordx4 v[108:111], v5, s[44:47], s64 offen nt
  s_add_u32 s64, s64, s63
  buffer_load_dwordx4 v[112:115], v5, s[44:47], s64 offen nt
  s_add_u32 s64, s64, s63
  buffer_load_dwordx4 v[116:119], v5, s[44:47], s64 offen nt
  s_add_u32 s64, s64, s63
  buffer_load_dwordx4 v[120:123], v5, s[44:47], s64 offen nt
  s_add_u32 s64, s64, s63
  buffer_load_dwordx4 v[124:127], v5, s[44:47], s64 offen nt
  s_add_u32 s64, s64, s63
  buffer_load_dwordx4 v[128:131], v5, s[44:47], s64 offen nt
  s_add_u32 s64, s64, s63
  buffer_load_dwordx4 v[132:135], v5, s[44:47], s64 offen nt
  s_add_u32 s64, s64, s63
  buffer_load_dwordx4 v[136:139], v5, s[44:47], s64 offen nt
  s_add_u32 s64, s64, s63
  buffer_load_dwordx4 v[140:143], v5, s[44:47], s64 offen nt
  s_add_u32 s64, s64, s63
  buffer_load_dwordx4 v[144:147], v5, s[44:47], s64 offen nt
  s_add_u32 s64, s64, s63
  buffer_load_dwordx4 v[148:151], v5, s[44:47], s64 offen nt
  s_add_u32 s64, s64, s63
  buffer_load_dwordx4 v[152:155], v5, s[44:47], s64 offen nt
  s_add_u32 s64, s64, s63
  buffer_load_dwordx4 v[156:159], v5, s[44:47], s64 offen nt
  s_add_u32 s64, s64, s63
  buffer_load_dwordx4 v[160:163], v5, s[44:47], s64 offen nt
  s_add_u32 s64, s64, s63
  buffer_load_dwordx4 v[164:167], v5, s[44:47], s64 offen nt
  v_lshlrev_b32 v3, 4, v0
  v_add_u32 v3, s11, v3
  v_and_b32 v4, 3, v0
  v_lshlrev_b32 v4, 10, v4
  v_lshl_add_u32 v4, v2, 4, v4
  s_lshl_b32 s70, s68, 9
  s_add_u32 s70, s70, 134208
  v_add_u32 v4, s70, v4
  v_lshrrev_b32 v8, 2, v1
  v_lshl_add_u32 v8, v2, 3, v8
  v_lshlrev_b32 v8, 7, v8
  v_and_b32 v9, 3, v1
  v_lshl_add_u32 v5, v9, 3, v8
  v_add_u32 v5, s11, v5
  v_lshrrev_b32 v8, 2, v1
  v_cmp_eq_u32 s[74:75], 1, v8
  v_cmp_eq_u32 s[76:77], 2, v8
  v_cmp_eq_u32 s[78:79], 3, v8
  s_waitcnt lgkmcnt(0)
  s_add_u32 s58, s58, 1
  s_addc_u32 s59, s59, 0
  s_waitcnt vmcnt(28)
  ds_write_b128 v3, v[40:43] offset:0
  ds_write_b128 v3, v[44:47] offset:1024
  ds_write_b128 v3, v[48:51] offset:2048
  ds_write_b128 v3, v[52:55] offset:3072
  ds_read_b64_tr_b16 v[40:41], v5 offset:0
  ds_read_b64_tr_b16 v[42:43], v5 offset:512
  ds_read_b64_tr_b16 v[44:45], v5 offset:32
  ds_read_b64_tr_b16 v[46:47], v5 offset:544
  ds_read_b64_tr_b16 v[48:49], v5 offset:64
  ds_read_b64_tr_b16 v[50:51], v5 offset:576
  ds_read_b64_tr_b16 v[52:53], v5 offset:96
  ds_read_b64_tr_b16 v[54:55], v5 offset:608
  s_waitcnt vmcnt(24)
  ds_write_b128 v3, v[56:59] offset:4096
  ds_write_b128 v3, v[60:63] offset:5120
  ds_write_b128 v3, v[64:67] offset:6144
  ds_write_b128 v3, v[68:71] offset:7168
  ds_read_b64_tr_b16 v[56:57], v5 offset:4096
  ds_read_b64_tr_b16 v[58:59], v5 offset:4608
  ds_read_b64_tr_b16 v[60:61], v5 offset:4128
  ds_read_b64_tr_b16 v[62:63], v5 offset:4640
  ds_read_b64_tr_b16 v[64:65], v5 offset:4160
  ds_read_b64_tr_b16 v[66:67], v5 offset:4672
  ds_read_b64_tr_b16 v[68:69], v5 offset:4192
  ds_read_b64_tr_b16 v[70:71], v5 offset:4704
  s_waitcnt vmcnt(20)
  ds_write_b128 v3, v[72:75] offset:0
  ds_write_b128 v3, v[76:79] offset:1024
  ds_write_b128 v3, v[80:83] offset:2048
  ds_write_b128 v3, v[84:87] offset:3072
  ds_read_b64_tr_b16 v[72:73], v5 offset:0
  ds_read_b64_tr_b16 v[74:75], v5 offset:512
  ds_read_b64_tr_b16 v[76:77], v5 offset:32
  ds_read_b64_tr_b16 v[78:79], v5 offset:544
  ds_read_b64_tr_b16 v[80:81], v5 offset:64
  ds_read_b64_tr_b16 v[82:83], v5 offset:576
  ds_read_b64_tr_b16 v[84:85], v5 offset:96
  ds_read_b64_tr_b16 v[86:87], v5 offset:608
  s_waitcnt vmcnt(16)
  ds_write_b128 v3, v[88:91] offset:4096
  ds_write_b128 v3, v[92:95] offset:5120
  ds_write_b128 v3, v[96:99] offset:6144
  ds_write_b128 v3, v[100:103] offset:7168
  ds_read_b64_tr_b16 v[88:89], v5 offset:4096
  ds_read_b64_tr_b16 v[90:91], v5 offset:4608
  ds_read_b64_tr_b16 v[92:93], v5 offset:4128
  ds_read_b64_tr_b16 v[94:95], v5 offset:4640
  ds_read_b64_tr_b16 v[96:97], v5 offset:4160
  ds_read_b64_tr_b16 v[98:99], v5 offset:4672
  ds_read_b64_tr_b16 v[100:101], v5 offset:4192
  ds_read_b64_tr_b16 v[102:103], v5 offset:4704
  s_waitcnt vmcnt(12)
  ds_write_b128 v3, v[104:107] offset:0
  ds_write_b128 v3, v[108:111] offset:1024
  ds_write_b128 v3, v[112:115] offset:2048
  ds_write_b128 v3, v[116:119] offset:3072
  ds_read_b64_tr_b16 v[104:105], v5 offset:0
  ds_read_b64_tr_b16 v[106:107], v5 offset:512
  ds_read_b64_tr_b16 v[108:109], v5 offset:32
  ds_read_b64_tr_b16 v[110:111], v5 offset:544
  ds_read_b64_tr_b16 v[112:113], v5 offset:64
  ds_read_b64_tr_b16 v[114:115], v5 offset:576
  ds_read_b64_tr_b16 v[116:117], v5 offset:96
  ds_read_b64_tr_b16 v[118:119], v5 offset:608
  s_waitcnt vmcnt(8)
  ds_write_b128 v3, v[120:123] offset:4096
  ds_write_b128 v3, v[124:127] offset:5120
  ds_write_b128 v3, v[128:131] offset:6144
  ds_write_b128 v3, v[132:135] offset:7168
  ds_read_b64_tr_b16 v[120:121], v5 offset:4096
  ds_read_b64_tr_b16 v[122:123], v5 offset:4608
  ds_read_b64_tr_b16 v[124:125], v5 offset:4128
  ds_read_b64_tr_b16 v[126:127], v5 offset:4640
  ds_read_b64_tr_b16 v[128:129], v5 offset:4160
  ds_read_b64_tr_b16 v[130:131], v5 offset:4672
  ds_read_b64_tr_b16 v[132:133], v5 offset:4192
  ds_read_b64_tr_b16 v[134:135], v5 offset:4704
  s_waitcnt vmcnt(4)
  ds_write_b128 v3, v[136:139] offset:0
  ds_write_b128 v3, v[140:143] offset:1024
  ds_write_b128 v3, v[144:147] offset:2048
  ds_write_b128 v3, v[148:151] offset:3072
  ds_read_b64_tr_b16 v[136:137], v5 offset:0
  ds_read_b64_tr_b16 v[138:139], v5 offset:512
  ds_read_b64_tr_b16 v[140:141], v5 offset:32
  ds_read_b64_tr_b16 v[142:143], v5 offset:544
  ds_read_b64_tr_b16 v[144:145], v5 offset:64
  ds_read_b64_tr_b16 v[146:147], v5 offset:576
  ds_read_b64_tr_b16 v[148:149], v5 offset:96
  ds_read_b64_tr_b16 v[150:151], v5 offset:608
  s_waitcnt vmcnt(0)
  ds_write_b128 v3, v[152:155] offset:4096
  ds_write_b128 v3, v[156:159] offset:5120
  ds_write_b128 v3, v[160:163] offset:6144
  ds_write_b128 v3, v[164:167] offset:7168
  ds_read_b64_tr_b16 v[152:153], v5 offset:4096
  ds_read_b64_tr_b16 v[154:155], v5 offset:4608
  ds_read_b64_tr_b16 v[156:157], v5 offset:4128
  ds_read_b64_tr_b16 v[158:159], v5 offset:4640
  ds_read_b64_tr_b16 v[160:161], v5 offset:4160
  ds_read_b64_tr_b16 v[162:163], v5 offset:4672
  ds_read_b64_tr_b16 v[164:165], v5 offset:4192
  ds_read_b64_tr_b16 v[166:167], v5 offset:4704
  v_mov_b32 v8, 133632
  s_mov_b32 s72, 3200000
L_xnwait:
  ds_read_b32 v10, v8
  s_waitcnt lgkmcnt(0)
  s_sub_u32 s72, s72, 1
  s_cbranch_scc1 L_xnwait_out
  v_cmp_ne_u32 vcc, 1, v10
  s_cbranch_vccz L_xnwait_out
  s_sleep 1
  s_branch L_xnwait
L_xnwait_out:
  ds_read_b128 v[8:11], v4 offset:0
  ds_read_b128 v[12:15], v4 offset:64
  ds_read_b128 v[32:35], v4 offset:128
  ds_read_b128 v[36:39], v4 offset:192
  s_waitcnt lgkmcnt(3)
  v_mfma_f32_16x16x32_bf16 v[16:19], v[40:43], v[8:11], 0
  v_mfma_f32_16x16x32_bf16 v[20:23], v[44:47], v[8:11], 0
  v_mfma_f32_16x16x32_bf16 v[24:27], v[48:51], v[8:11], 0
  v_mfma_f32_16x16x32_bf16 v[28:31], v[52:55], v[8:11], 0
  ds_read_b128 v[8:11], v4 offset:256
  s_waitcnt lgkmcnt(3)
  v_mfma_f32_16x16x32_bf16 v[16:19], v[56:59], v[12:15], v[16:19]
  v_mfma_f32_16x16x32_bf16 v[20:23], v[60:63], v[12:15], v[20:23]
  v_mfma_f32_16x16x32_bf16 v[24:27], v[64:67], v[12:15], v[24:27]
  v_mfma_f32_16x16x32_bf16 v[28:31], v[68:71], v[12:15], v[28:31]
  ds_read_b128 v[12:15], v4 offset:320
  s_waitcnt lgkmcnt(3)
  v_mfma_f32_16x16x32_bf16 v[16:19], v[72:75], v[32:35], v[16:19]
  v_mfma_f32_16x16x32_bf16 v[20:23], v[76:79], v[32:35], v[20:23]
  v_mfma_f32_16x16x32_bf16 v[24:27], v[80:83], v[32:35], v[24:27]
  v_mfma_f32_16x16x32_bf16 v[28:31], v[84:87], v[32:35], v[28:31]
  ds_read_b128 v[32:35], v4 offset:384
  s_waitcnt lgkmcnt(3)
  v_mfma_f32_16x16x32_bf16 v[16:19], v[88:91], v[36:39], v[16:19]
  v_mfma_f32_16x16x32_bf16 v[20:23], v[92:95], v[36:39], v[20:23]
  v_mfma_f32_16x16x32_bf16 v[24:27], v[96:99], v[36:39], v[24:27]
  v_mfma_f32_16x16x32_bf16 v[28:31], v[100:103], v[36:39], v[28:31]
  ds_read_b128 v[36:39], v4 offset:448
  s_waitcnt lgkmcnt(3)
  v_mfma_f32_16x16x32_bf16 v[16:19], v[104:107], v[8:11], v[16:19]
  v_mfma_f32_16x16x32_bf16 v[20:23], v[108:111], v[8:11], v[20:23]
  v_mfma_f32_16x16x32_bf16 v[24:27], v[112:115], v[8:11], v[24:27]
  v_mfma_f32_16x16x32_bf16 v[28:31], v[116:119], v[8:11], v[28:31]
  s_waitcnt lgkmcnt(2)
  v_mfma_f32_16x16x32_bf16 v[16:19], v[120:123], v[12:15], v[16:19]
  v_mfma_f32_16x16x32_bf16 v[20:23], v[124:127], v[12:15], v[20:23]
  v_mfma_f32_16x16x32_bf16 v[24:27], v[128:131], v[12:15], v[24:27]
  v_mfma_f32_16x16x32_bf16 v[28:31], v[132:135], v[12:15], v[28:31]
  s_waitcnt lgkmcnt(1)
  v_mfma_f32_16x16x32_bf16 v[16:19], v[136:139], v[32:35], v[16:19]
  v_mfma_f32_16x16x32_bf16 v[20:23], v[140:143], v[32:35], v[20:23]
  v_mfma_f32_16x16x32_bf16 v[24:27], v[144:147], v[32:35], v[24:27]
  v_mfma_f32_16x16x32_bf16 v[28:31], v[148:151], v[32:35], v[28:31]
  s_waitcnt lgkmcnt(0)
  v_mfma_f32_16x16x32_bf16 v[16:19], v[152:155], v[36:39], v[16:19]
  v_mfma_f32_16x16x32_bf16 v[20:23], v[156:159], v[36:39], v[20:23]
  v_mfma_f32_16x16x32_bf16 v[24:27], v[160:163], v[36:39], v[24:27]
  v_mfma_f32_16x16x32_bf16 v[28:31], v[164:167], v[36:39], v[28:31]
  s_nop 5
  v_cndmask_b32 v16, v16, v20, s[74:75]
  s_nop 0
  v_cndmask_b32 v24, v24, v28, s[78:79]
  v_cndmask_b32 v17, v17, v21, s[74:75]
  v_cndmask_b32 v25, v25, v29, s[78:79]
  v_cndmask_b32 v18, v18, v22, s[74:75]
  v_cndmask_b32 v26, v26, v30, s[78:79]
  v_cndmask_b32 v19, v19, v23, s[74:75]
  v_cndmask_b32 v27, v27, v31, s[78:79]
  s_or_b64 s[76:77], s[76:77], s[78:79]
  v_cndmask_b32 v32, v16, v24, s[76:77]
  v_cndmask_b32 v33, v17, v25, s[76:77]
  v_cndmask_b32 v36, v18, v26, s[76:77]
  v_cndmask_b32 v37, v19, v27, s[76:77]
  v_mov_b32 v34, s58
  v_mov_b32 v35, s59
  v_mov_b32 v38, s58
  v_mov_b32 v39, s59
  s_cmp_ge_u32 s14, 16
  s_cbranch_scc1 L_pub_b
  buffer_store_dwordx4 v[32:35], v6, s[48:51], s66 offen
  buffer_store_dwordx4 v[36:39], v7, s[48:51], s66 offen
  s_add_u32 s66, s66, 3604480
L_pub_b:
  buffer_store_dwordx4 v[32:35], v6, s[48:51], s66 offen sc1
  buffer_store_dwordx4 v[36:39], v7, s[48:51], s66 offen sc1
  s_branch L_pre_b1
L_s1:
  v_lshlrev_b32 v3, 6, v0
  buffer_load_dwordx4 v[16:19], v3, s[40:43], 0 offen offset:0
  buffer_load_dwordx4 v[20:23], v3, s[40:43], 0 offen offset:16
  buffer_load_dwordx4 v[24:27], v3, s[40:43], 0 offen offset:32
  buffer_load_dwordx4 v[28:31], v3, s[40:43], 0 offen offset:48
  v_add_u32 v3, 134208, v3
  v_mov_b32 v8, 133632
  v_mov_b32 v10, 0
  ds_write_b32 v8, v10
  s_waitcnt lgkmcnt(0)
  s_barrier
  s_add_u32 s58, s58, 1
  s_addc_u32 s59, s59, 0
  s_waitcnt vmcnt(0)
  v_lshlrev_b32 v128, 16, v16
  v_and_b32 v129, s62, v16
  v_lshlrev_b32 v130, 16, v17
  v_and_b32 v131, s62, v17
  v_lshlrev_b32 v132, 16, v18
  v_and_b32 v133, s62, v18
  v_lshlrev_b32 v134, 16, v19
  v_and_b32 v135, s62, v19
  v_lshlrev_b32 v136, 16, v20
  v_and_b32 v137, s62, v20
  v_lshlrev_b32 v138, 16, v21
  v_and_b32 v139, s62, v21
  v_lshlrev_b32 v140, 16, v22
  v_and_b32 v141, s62, v22
  v_lshlrev_b32 v142, 16, v23
  v_and_b32 v143, s62, v23
  v_lshlrev_b32 v144, 16, v24
  v_and_b32 v145, s62, v24
  v_lshlrev_b32 v146, 16, v25
  v_and_b32 v147, s62, v25
  v_lshlrev_b32 v148, 16, v26
  v_and_b32 v149, s62, v26
  v_lshlrev_b32 v150, 16, v27
  v_and_b32 v151, s62, v27
  v_lshlrev_b32 v152, 16, v28
  v_and_b32 v153, s62, v28
  v_lshlrev_b32 v154, 16, v29
  v_and_b32 v155, s62, v29
  v_lshlrev_b32 v156, 16, v30
  v_and_b32 v157, s62, v30
  v_lshlrev_b32 v158, 16, v31
  v_and_b32 v159, s62, v31
  v_pk_add_f32 v[8:9], v[128:129], v[130:131]
  v_pk_add_f32 v[10:11], v[132:133], v[134:135]
  v_pk_add_f32 v[8:9], v[8:9], v[136:137]
  v_pk_add_f32 v[10:11], v[10:11], v[138:139]
  v_pk_add_f32 v[8:9], v[8:9], v[140:141]
  v_pk_add_f32 v[10:11], v[10:11], v[142:143]
  v_pk_add_f32 v[8:9], v[8:9], v[144:145]
  v_pk_add_f32 v[10:11], v[10:11], v[146:147]
  v_pk_add_f32 v[8:9], v[8:9], v[148:149]
  v_pk_add_f32 v[10:11], v[10:11], v[150:151]
  v_pk_add_f32 v[8:9], v[8:9], v[152:153]
  v_pk_add_f32 v[10:11], v[10:11], v[154:155]
  v_pk_add_f32 v[8:9], v[8:9], v[156:157]
  v_pk_add_f32 v[10:11], v[10:11], v[158:159]
  v_pk_add_f32 v[8:9], v[8:9], v[10:11]
  v_add_f32 v8, v8, v9
  s_nop 1
  v_add_f32 v8, v8, v8 row_ror:1 row_mask:0xf bank_mask:0xf
  s_nop 1
  v_add_f32 v8, v8, v8 row_ror:2 row_mask:0xf bank_mask:0xf
  s_nop 1
  v_add_f32 v8, v8, v8 row_ror:4 row_mask:0xf bank_mask:0xf
  s_nop 1
  v_add_f32 v8, v8, v8 row_ror:8 row_mask:0xf bank_mask:0xf
  v_mul_f32 v8, 0xbb000000, v8
  v_mov_b32 v9, v8
  v_pk_add_f32 v[32:33], v[128:129], v[8:9]
  v_pk_mul_f32 v[10:11], v[32:33], v[32:33]
  v_pk_add_f32 v[34:35], v[130:131], v[8:9]
  v_pk_mul_f32 v[12:13], v[34:35], v[34:35]
  v_pk_add_f32 v[36:37], v[132:133], v[8:9]
  v_pk_fma_f32 v[10:11], v[36:37], v[36:37], v[10:11]
  v_pk_add_f32 v[38:39], v[134:135], v[8:9]
  v_pk_fma_f32 v[12:13], v[38:39], v[38:39], v[12:13]
  v_pk_add_f32 v[32:33], v[136:137], v[8:9]
  v_pk_fma_f32 v[10:11], v[32:33], v[32:33], v[10:11]
  v_pk_add_f32 v[34:35], v[138:139], v[8:9]
  v_pk_fma_f32 v[12:13], v[34:35], v[34:35], v[12:13]
  v_pk_add_f32 v[36:37], v[140:141], v[8:9]
  v_pk_fma_f32 v[10:11], v[36:37], v[36:37], v[10:11]
  v_pk_add_f32 v[38:39], v[142:143], v[8:9]
  v_pk_fma_f32 v[12:13], v[38:39], v[38:39], v[12:13]
  v_pk_add_f32 v[32:33], v[144:145], v[8:9]
  v_pk_fma_f32 v[10:11], v[32:33], v[32:33], v[10:11]
  v_pk_add_f32 v[34:35], v[146:147], v[8:9]
  v_pk_fma_f32 v[12:13], v[34:35], v[34:35], v[12:13]
  v_pk_add_f32 v[36:37], v[148:149], v[8:9]
  v_pk_fma_f32 v[10:11], v[36:37], v[36:37], v[10:11]
  v_pk_add_f32 v[38:39], v[150:151], v[8:9]
  v_pk_fma_f32 v[12:13], v[38:39], v[38:39], v[12:13]
  v_pk_add_f32 v[32:33], v[152:153], v[8:9]
  v_pk_fma_f32 v[10:11], v[32:33], v[32:33], v[10:11]
  v_pk_add_f32 v[34:35], v[154:155], v[8:9]
  v_pk_fma_f32 v[12:13], v[34:35], v[34:35], v[12:13]
  v_pk_add_f32 v[36:37], v[156:157], v[8:9]
  v_pk_fma_f32 v[10:11], v[36:37], v[36:37], v[10:11]
  v_pk_add_f32 v[38:39], v[158:159], v[8:9]
  v_pk_fma_f32 v[12:13], v[38:39], v[38:39], v[12:13]
  v_pk_add_f32 v[10:11], v[10:11], v[12:13]
  v_add_f32 v9, v10, v11
  s_nop 1
  v_add_f32 v9, v9, v9 row_ror:1 row_mask:0xf bank_mask:0xf
  s_nop 1
  v_add_f32 v9, v9, v9 row_ror:2 row_mask:0xf bank_mask:0xf
  s_nop 1
  v_add_f32 v9, v9, v9 row_ror:4 row_mask:0xf bank_mask:0xf
  s_nop 1
  v_add_f32 v9, v9, v9 row_ror:8 row_mask:0xf bank_mask:0xf
  v_mul_f32 v9, 0x3b000000, v9
  v_cvt_pk_bf16_f32 v10, v8, v9
  v_lshlrev_b32 v8, 16, v10
  v_and_b32 v9, s62, v10
  v_add_f32 v9, 0x3727c5ac, v9
  v_cvt_pk_bf16_f32 v10, v9, v9
  v_lshlrev_b32 v9, 16, v10
  v_sqrt_f32 v9, v9
  s_nop 0
  v_cvt_pk_bf16_f32 v10, v9, v9
  v_lshlrev_b32 v9, 16, v10
  v_rcp_f32 v10, v9
  v_mov_b32 v9, v8
  v_mov_b32 v11, v10
  v_pk_add_f32 v[128:129], v[128:129], v[8:9]
  v_pk_add_f32 v[130:131], v[130:131], v[8:9]
  v_pk_add_f32 v[132:133], v[132:133], v[8:9]
  v_pk_add_f32 v[134:135], v[134:135], v[8:9]
  v_pk_add_f32 v[136:137], v[136:137], v[8:9]
  v_pk_add_f32 v[138:139], v[138:139], v[8:9]
  v_pk_add_f32 v[140:141], v[140:141], v[8:9]
  v_pk_add_f32 v[142:143], v[142:143], v[8:9]
  v_pk_add_f32 v[144:145], v[144:145], v[8:9]
  v_pk_add_f32 v[146:147], v[146:147], v[8:9]
  v_pk_add_f32 v[148:149], v[148:149], v[8:9]
  v_pk_add_f32 v[150:151], v[150:151], v[8:9]
  v_pk_add_f32 v[152:153], v[152:153], v[8:9]
  v_pk_add_f32 v[154:155], v[154:155], v[8:9]
  v_pk_add_f32 v[156:157], v[156:157], v[8:9]
  v_pk_add_f32 v[158:159], v[158:159], v[8:9]
  v_cvt_pk_bf16_f32 v16, v128, v129
  v_cvt_pk_bf16_f32 v17, v130, v131
  v_cvt_pk_bf16_f32 v18, v132, v133
  v_cvt_pk_bf16_f32 v19, v134, v135
  v_cvt_pk_bf16_f32 v20, v136, v137
  v_cvt_pk_bf16_f32 v21, v138, v139
  v_cvt_pk_bf16_f32 v22, v140, v141
  v_cvt_pk_bf16_f32 v23, v142, v143
  v_cvt_pk_bf16_f32 v24, v144, v145
  v_cvt_pk_bf16_f32 v25, v146, v147
  v_cvt_pk_bf16_f32 v26, v148, v149
  v_cvt_pk_bf16_f32 v27, v150, v151
  v_cvt_pk_bf16_f32 v28, v152, v153
  v_cvt_pk_bf16_f32 v29, v154, v155
  v_cvt_pk_bf16_f32 v30, v156, v157
  v_cvt_pk_bf16_f32 v31, v158, v159
  v_lshlrev_b32 v128, 16, v16
  v_and_b32 v129, s62, v16
  v_lshlrev_b32 v130, 16, v17
  v_and_b32 v131, s62, v17
  v_lshlrev_b32 v132, 16, v18
  v_and_b32 v133, s62, v18
  v_lshlrev_b32 v134, 16, v19
  v_and_b32 v135, s62, v19
  v_lshlrev_b32 v136, 16, v20
  v_and_b32 v137, s62, v20
  v_lshlrev_b32 v138, 16, v21
  v_and_b32 v139, s62, v21
  v_lshlrev_b32 v140, 16, v22
  v_and_b32 v141, s62, v22
  v_lshlrev_b32 v142, 16, v23
  v_and_b32 v143, s62, v23
  v_lshlrev_b32 v144, 16, v24
  v_and_b32 v145, s62, v24
  v_lshlrev_b32 v146, 16, v25
  v_and_b32 v147, s62, v25
  v_lshlrev_b32 v148, 16, v26
  v_and_b32 v149, s62, v26
  v_lshlrev_b32 v150, 16, v27
  v_and_b32 v151, s62, v27
  v_lshlrev_b32 v152, 16, v28
  v_and_b32 v153, s62, v28
  v_lshlrev_b32 v154, 16, v29
  v_and_b32 v155, s62, v29
  v_lshlrev_b32 v156, 16, v30
  v_and_b32 v157, s62, v30
  v_lshlrev_b32 v158, 16, v31
  v_and_b32 v159, s62, v31
  v_pk_mul_f32 v[128:129], v[128:129], v[10:11]
  v_pk_mul_f32 v[130:131], v[130:131], v[10:11]
  v_pk_mul_f32 v[132:133], v[132:133], v[10:11]
  v_pk_mul_f32 v[134:135], v[134:135], v[10:11]
  v_pk_mul_f32 v[136:137], v[136:137], v[10:11]
  v_pk_mul_f32 v[138:139], v[138:139], v[10:11]
  v_pk_mul_f32 v[140:141], v[140:141], v[10:11]
  v_pk_mul_f32 v[142:143], v[142:143], v[10:11]
  v_pk_mul_f32 v[144:145], v[144:145], v[10:11]
  v_pk_mul_f32 v[146:147], v[146:147], v[10:11]
  v_pk_mul_f32 v[148:149], v[148:149], v[10:11]
  v_pk_mul_f32 v[150:151], v[150:151], v[10:11]
  v_pk_mul_f32 v[152:153], v[152:153], v[10:11]
  v_pk_mul_f32 v[154:155], v[154:155], v[10:11]
  v_pk_mul_f32 v[156:157], v[156:157], v[10:11]
  v_pk_mul_f32 v[158:159], v[158:159], v[10:11]
  v_cvt_pk_bf16_f32 v16, v128, v129
  v_cvt_pk_bf16_f32 v17, v130, v131
  v_cvt_pk_bf16_f32 v18, v132, v133
  v_cvt_pk_bf16_f32 v19, v134, v135
  v_cvt_pk_bf16_f32 v20, v136, v137
  v_cvt_pk_bf16_f32 v21, v138, v139
  v_cvt_pk_bf16_f32 v22, v140, v141
  v_cvt_pk_bf16_f32 v23, v142, v143
  v_cvt_pk_bf16_f32 v24, v144, v145
  v_cvt_pk_bf16_f32 v25, v146, v147
  v_cvt_pk_bf16_f32 v26, v148, v149
  v_cvt_pk_bf16_f32 v27, v150, v151
  v_cvt_pk_bf16_f32 v28, v152, v153
  v_cvt_pk_bf16_f32 v29, v154, v155
  v_cvt_pk_bf16_f32 v30, v156, v157
  v_cvt_pk_bf16_f32 v31, v158, v159
  ds_write_b128 v3, v[16:19] offset:0
  ds_write_b128 v3, v[20:23] offset:16
  ds_write_b128 v3, v[24:27] offset:32
  ds_write_b128 v3, v[28:31] offset:48
  v_mov_b32 v8, 133632
  v_mov_b32 v10, 1
  s_waitcnt lgkmcnt(0)
  ds_write_b32 v8, v10
  s_branch L_pre_b1
L_s2:
  s_barrier
  s_waitcnt lgkmcnt(0)
  s_add_u32 s58, s58, 1
  s_addc_u32 s59, s59, 0
  s_lshl_b32 s70, s4, 15
  s_lshl_b32 s71, s6, 13
  s_add_u32 s70, s70, s71
  s_add_u32 s70, s70, 65536
  s_add_u32 s71, s70, 4096
  v_lshlrev_b32 v8, 4, v0
  v_lshrrev_b32 v9, 5, v0
  v_lshlrev_b32 v9, 7, v9
  v_lshl_add_u32 v9, v1, 3, v9
  v_and_b32 v10, 1, v2
  v_lshl_add_u32 v9, v10, 2, v9
  v_add_u32 v9, 131072, v9
  s_mov_b32 s72, 399999
  s_sleep 40
L_poll1:
  s_and_b32 s73, s72, 7
  s_cselect_b32 s73, 0, 3604480
  s_add_u32 s76, s70, s73
  s_add_u32 s77, s71, s73
  buffer_load_dwordx4 v[16:19], v8, s[48:51], s76 offen offset:0 sc1
  buffer_load_dwordx4 v[20:23], v8, s[48:51], s76 offen offset:1024 sc1
  buffer_load_dwordx4 v[24:27], v8, s[48:51], s76 offen offset:2048 sc1
  buffer_load_dwordx4 v[28:31], v8, s[48:51], s76 offen offset:3072 sc1
  buffer_load_dwordx4 v[32:35], v8, s[48:51], s77 offen offset:0 sc1
  buffer_load_dwordx4 v[36:39], v8, s[48:51], s77 offen offset:1024 sc1
  buffer_load_dwordx4 v[40:43], v8, s[48:51], s77 offen offset:2048 sc1
  buffer_load_dwordx4 v[44:47], v8, s[48:51], s77 offen offset:3072 sc1
  s_waitcnt vmcnt(0)
  v_cmp_ne_u64 vcc, s[58:59], v[18:19]
  v_cmp_ne_u64 s[74:75], s[58:59], v[22:23]
  s_nop 0
  s_or_b64 vcc, vcc, s[74:75]
  v_cmp_ne_u64 s[74:75], s[58:59], v[26:27]
  s_nop 0
  s_or_b64 vcc, vcc, s[74:75]
  v_cmp_ne_u64 s[74:75], s[58:59], v[30:31]
  s_nop 0
  s_or_b64 vcc, vcc, s[74:75]
  v_cmp_ne_u64 s[74:75], s[58:59], v[34:35]
  s_nop 0
  s_or_b64 vcc, vcc, s[74:75]
  v_cmp_ne_u64 s[74:75], s[58:59], v[38:39]
  s_nop 0
  s_or_b64 vcc, vcc, s[74:75]
  v_cmp_ne_u64 s[74:75], s[58:59], v[42:43]
  s_nop 0
  s_or_b64 vcc, vcc, s[74:75]
  v_cmp_ne_u64 s[74:75], s[58:59], v[46:47]
  s_nop 0
  s_or_b64 vcc, vcc, s[74:75]
  s_sub_u32 s72, s72, 1
  s_cbranch_scc1 L_poll1_out
  s_cbranch_vccz L_poll1_out
  s_sleep 2
  s_branch L_poll1
L_poll1_out:
  v_add_f32 v16, v16, v32
  v_add_f32 v17, v17, v33
  v_cvt_pk_bf16_f32 v16, v16, v17
  ds_write_b32 v9, v16 offset:0
  v_add_f32 v20, v20, v36
  v_add_f32 v21, v21, v37
  v_cvt_pk_bf16_f32 v20, v20, v21
  ds_write_b32 v9, v20 offset:256
  v_add_f32 v24, v24, v40
  v_add_f32 v25, v25, v41
  v_cvt_pk_bf16_f32 v24, v24, v25
  ds_write_b32 v9, v24 offset:512
  v_add_f32 v28, v28, v44
  v_add_f32 v29, v29, v45
  v_cvt_pk_bf16_f32 v28, v28, v29
  ds_write_b32 v9, v28 offset:768
  s_branch L_pre_b1
L_s3:
  s_barrier
  s_waitcnt lgkmcnt(0)
  s_add_u32 s58, s58, 1
  s_addc_u32 s59, s59, 0
L_pre_b1:
  s_waitcnt lgkmcnt(0)
  s_barrier
  v_bfe_u32 v110, v1, 1, 2
  v_mul_u32_u24 v110, 384, v110
  v_and_b32 v111, 1, v1
  v_lshl_add_u32 v110, v111, 3, v110
  v_lshrrev_b32 v111, 3, v1
  v_lshl_add_u32 v110, v111, 2, v110
  v_add_u32 v110, 132352, v110
  s_mov_b32 s56, 57344
  v_mul_lo_u32 v111, v2, s56
  v_lshl_add_u32 v111, v1, 4, v111
  s_lshl_b32 s57, s4, 2
  s_add_u32 s57, s57, s6
  s_mul_i32 s57, s57, 1792
  s_add_u32 s57, s57, 327680
  s_cmp_eq_u32 s3, 1
  s_cbranch_scc0 L_no_ffn_early
  v_mov_b32 v113, 0
  ds_write_b32 v110, v113 offset:112
  buffer_load_dwordx4 v[116:119], v111, s[48:51], s57 offen offset:0 sc1
  buffer_load_dwordx4 v[120:123], v111, s[48:51], s57 offen offset:256 sc1
  buffer_load_dwordx4 v[124:127], v111, s[48:51], s57 offen offset:512 sc1
  buffer_load_dwordx4 v[128:131], v111, s[48:51], s57 offen offset:768 sc1
  buffer_load_dwordx4 v[132:135], v111, s[48:51], s57 offen offset:1024 sc1
  buffer_load_dwordx4 v[136:139], v111, s[48:51], s57 offen offset:1280 sc1
  buffer_load_dwordx4 v[140:143], v111, s[48:51], s57 offen offset:1536 sc1
L_no_ffn_early:
  s_mov_b32 s52, s34
  s_and_b32 s53, s35, 0xffff
  s_mov_b32 s54, 4096
  s_mov_b32 s55, 0x20000
  s_bfe_u32 s11, s2, 0x20001
  s_lshl_b32 s11, s11, 10
  s_lshr_b32 s70, s2, 3
  s_lshl_b32 s70, s70, 7
  s_add_u32 s11, s11, s70
  s_and_b32 s70, s2, 1
  s_lshl_b32 s70, s70, 6
  s_add_u32 s11, s11, s70
  v_and_b32 v61, 7, v0
  v_lshlrev_b32 v60, 4, v61
  v_lshlrev_b32 v61, 3, v61
  buffer_load_dwordx2 v[56:57], v61, s[40:43], s11 offen
  v_and_b32 v8, 31, v0
  v_lshlrev_b32 v9, 4, v8
  s_lshl_b32 s70, s3, 9
  v_and_b32 v10, 7, v8
  v_and_b32 v11, 3, v8
  v_xor_b32 v11, s3, v11
  v_lshlrev_b32 v10, 8, v10
  v_lshl_add_u32 v10, v11, 6, v10
  v_lshrrev_b32 v11, 3, v8
  v_lshl_add_u32 v10, v11, 4, v10
  v_add_u32 v11, 0x10000, v10
  s_lshl_b32 s71, s3, 3
  v_mov_b32 v12, s71
  v_add_u32 v13, 0x10000, v12
  s_lshl_b32 s68, s9, 11
  s_add_u32 s68, s68, s70
  s_add_u32 s68, s68, 589824
  s_add_u32 s63, s68, 3342336
  s_lshl_b32 s77, s4, 2
  s_add_u32 s77, s77, s6
  s_lshl_b32 s77, s77, 2
  s_add_u32 s77, s77, s3
  s_lshl_b32 s77, s77, 7
  s_add_u32 s77, s77, 1114112
  s_lshl_b32 s76, s7, 4
  s_add_u32 s76, s76, s77
  s_add_u32 s75, s76, 3342336
  s_lshl_b32 s64, s4, 5
  s_lshl_b32 s71, s3, 3
  s_add_u32 s64, s64, s71
  s_lshl_b32 s64, s64, 2
  s_add_u32 s64, s64, s6
  s_lshl_b32 s64, s64, 9
  s_add_u32 s64, s64, 589824
  v_lshrrev_b32 v14, 5, v0
  v_lshl_add_u32 v14, v14, 11, v9
  v_add_u32 v15, 4096, v14
  v_add_u32 v62, 8192, v14
  v_add_u32 v63, 12288, v14
  s_mul_i32 s70, s3, 384
  s_add_u32 s70, s70, 132096
  v_lshlrev_b32 v54, 3, v8
  v_add_u32 v54, s70, v54
  v_mov_b32 v90, s58
  v_mov_b32 v91, s59
  v_mov_b32 v86, s58
  v_mov_b32 v87, s59
  v_mov_b32 v55, 0
  s_lshl_b32 s65, s7, 2
  s_add_u32 s65, s65, s6
  s_lshl_b32 s65, s65, 11
  s_lshl_b32 s71, s4, 7
  s_add_u32 s65, s65, s71
  s_add_u32 s65, s65, 1310720
  s_lshl_b32 s66, s2, 10
  s_add_u32 s66, s66, 1310720
  v_lshlrev_b32 v52, 10, v0
  v_lshlrev_b32 v53, 4, v0
  v_lshlrev_b32 v58, 7, v0
  s_mul_i32 s67, s2, 4352
  s_add_u32 s67, s67, 1376256
  s_barrier
  ds_read_b64 v[64:65], v12 offset:2048
  ds_read_b64 v[66:67], v12 offset:18432
  ds_read_b64 v[68:69], v12 offset:34816
  ds_read_b64 v[70:71], v12 offset:51200
  ds_read_b64 v[72:73], v13 offset:2048
  ds_read_b64 v[74:75], v13 offset:18432
  ds_read_b64 v[76:77], v13 offset:34816
  ds_read_b64 v[78:79], v13 offset:51200
  s_waitcnt lgkmcnt(0)
  v_max3_f32 v80, v64, v66, v68
  v_max3_f32 v81, v70, v72, v74
  v_max3_f32 v80, v80, v76, v78
  v_max_f32 v80, v80, v81
  v_sub_f32 v16, v64, v80
  v_sub_f32 v17, v66, v80
  v_sub_f32 v18, v68, v80
  v_sub_f32 v19, v70, v80
  v_sub_f32 v20, v72, v80
  v_sub_f32 v21, v74, v80
  v_sub_f32 v22, v76, v80
  v_sub_f32 v23, v78, v80
  v_exp_f32 v16, v16
  v_exp_f32 v17, v17
  v_exp_f32 v18, v18
  v_exp_f32 v19, v19
  v_exp_f32 v20, v20
  v_exp_f32 v21, v21
  v_exp_f32 v22, v22
  v_exp_f32 v23, v23
  v_mul_f32 v81, v16, v65
  v_mul_f32 v82, v17, v67
  v_fmac_f32 v81, v18, v69
  v_fmac_f32 v82, v19, v71
  v_fmac_f32 v81, v20, v73
  v_fmac_f32 v82, v21, v75
  v_fmac_f32 v81, v22, v77
  v_fmac_f32 v82, v23, v79
  v_add_f32 v81, v81, v82
  v_log_f32 v84, v81
  v_rcp_f32 v82, v81
  v_add_f32 v84, v84, v80
  s_mov_b64 exec, 1
  buffer_store_dwordx4 v[84:87], v55, s[48:51], s76 offen
  buffer_store_dwordx4 v[84:87], v55, s[48:51], s75 offen sc1
  s_mov_b64 exec, -1
  v_mul_f32 v64, v16, v82
  v_mul_f32 v65, v17, v82
  v_mul_f32 v66, v18, v82
  v_mul_f32 v67, v19, v82
  v_mul_f32 v68, v20, v82
  v_mul_f32 v69, v21, v82
  v_mul_f32 v70, v22, v82
  v_mul_f32 v71, v23, v82
  s_lshl_b32 s77, s4, 2
  s_add_u32 s77, s77, s3
  s_lshl_b32 s77, s77, 2
  s_add_u32 s77, s77, s6
  s_lshl_b32 s77, s77, 7
  s_add_u32 s77, s77, 1114112
  s_cmp_eq_u32 s3, 1
  s_cbranch_scc0 L_no_ffn_gather
  s_mov_b32 s72, 400000
  s_branch L_poll2_chk
L_poll2:
  buffer_load_dwordx4 v[116:119], v111, s[48:51], s57 offen offset:0 sc1
  buffer_load_dwordx4 v[120:123], v111, s[48:51], s57 offen offset:256 sc1
  buffer_load_dwordx4 v[124:127], v111, s[48:51], s57 offen offset:512 sc1
  buffer_load_dwordx4 v[128:131], v111, s[48:51], s57 offen offset:768 sc1
  buffer_load_dwordx4 v[132:135], v111, s[48:51], s57 offen offset:1024 sc1
  buffer_load_dwordx4 v[136:139], v111, s[48:51], s57 offen offset:1280 sc1
  buffer_load_dwordx4 v[140:143], v111, s[48:51], s57 offen offset:1536 sc1
L_poll2_chk:
  s_waitcnt vmcnt(0)
  v_cmp_ne_u64 vcc, s[58:59], v[118:119]
  v_cmp_ne_u64 s[74:75], s[58:59], v[122:123]
  s_nop 0
  s_or_b64 vcc, vcc, s[74:75]
  v_cmp_ne_u64 s[74:75], s[58:59], v[126:127]
  s_nop 0
  s_or_b64 vcc, vcc, s[74:75]
  v_cmp_ne_u64 s[74:75], s[58:59], v[130:131]
  s_nop 0
  s_or_b64 vcc, vcc, s[74:75]
  v_cmp_ne_u64 s[74:75], s[58:59], v[134:135]
  s_nop 0
  s_or_b64 vcc, vcc, s[74:75]
  v_cmp_ne_u64 s[74:75], s[58:59], v[138:139]
  s_nop 0
  s_or_b64 vcc, vcc, s[74:75]
  v_cmp_ne_u64 s[74:75], s[58:59], v[142:143]
  s_nop 0
  s_or_b64 vcc, vcc, s[74:75]
  s_sub_u32 s72, s72, 1
  s_cbranch_scc1 L_poll2_out
  s_cbranch_vccz L_poll2_out
  s_sleep 2
  s_branch L_poll2
L_poll2_out:
  v_mov_b32 v118, v116
  v_mov_b32 v119, v117
  v_mov_b32 v122, v120
  v_mov_b32 v123, v121
  v_mov_b32 v126, v124
  v_mov_b32 v127, v125
  v_mov_b32 v130, v128
  v_mov_b32 v131, v129
  v_mov_b32 v134, v132
  v_mov_b32 v135, v133
  v_mov_b32 v138, v136
  v_mov_b32 v139, v137
  v_mov_b32 v142, v140
  v_mov_b32 v143, v141
  v_permlane16_swap_b32 v116, v118
  v_permlane16_swap_b32 v117, v119
  v_permlane16_swap_b32 v120, v122
  v_permlane16_swap_b32 v121, v123
  v_permlane16_swap_b32 v124, v126
  v_permlane16_swap_b32 v125, v127
  v_permlane16_swap_b32 v128, v130
  v_permlane16_swap_b32 v129, v131
  v_permlane16_swap_b32 v132, v134
  v_permlane16_swap_b32 v133, v135
  v_permlane16_swap_b32 v136, v138
  v_permlane16_swap_b32 v137, v139
  v_permlane16_swap_b32 v140, v142
  v_permlane16_swap_b32 v141, v143
  v_add_f32 v116, v116, v118
  v_add_f32 v117, v117, v119
  v_add_f32 v120, v120, v122
  v_add_f32 v121, v121, v123
  v_add_f32 v124, v124, v126
  v_add_f32 v125, v125, v127
  v_add_f32 v128, v128, v130
  v_add_f32 v129, v129, v131
  v_add_f32 v132, v132, v134
  v_add_f32 v133, v133, v135
  v_add_f32 v136, v136, v138
  v_add_f32 v137, v137, v139
  v_add_f32 v140, v140, v142
  v_add_f32 v141, v141, v143
  v_cvt_pk_bf16_f32 v112, v116, v117
  v_lshlrev_b32 v116, 16, v112
  v_and_b32 v117, s62, v112
  v_cvt_pk_bf16_f32 v112, v120, v121
  v_lshlrev_b32 v120, 16, v112
  v_and_b32 v121, s62, v112
  v_cvt_pk_bf16_f32 v112, v124, v125
  v_lshlrev_b32 v124, 16, v112
  v_and_b32 v125, s62, v112
  v_cvt_pk_bf16_f32 v112, v128, v129
  v_lshlrev_b32 v128, 16, v112
  v_and_b32 v129, s62, v112
  v_cvt_pk_bf16_f32 v112, v132, v133
  v_lshlrev_b32 v132, 16, v112
  v_and_b32 v133, s62, v112
  v_cvt_pk_bf16_f32 v112, v136, v137
  v_lshlrev_b32 v136, 16, v112
  v_and_b32 v137, s62, v112
  v_cvt_pk_bf16_f32 v112, v140, v141
  v_lshlrev_b32 v140, 16, v112
  v_and_b32 v141, s62, v112
  v_mov_b32 v118, v116
  v_mov_b32 v119, v117
  v_mov_b32 v122, v120
  v_mov_b32 v123, v121
  v_mov_b32 v126, v124
  v_mov_b32 v127, v125
  v_mov_b32 v130, v128
  v_mov_b32 v131, v129
  v_mov_b32 v134, v132
  v_mov_b32 v135, v133
  v_mov_b32 v138, v136
  v_mov_b32 v139, v137
  v_mov_b32 v142, v140
  v_mov_b32 v143, v141
  v_permlane32_swap_b32 v116, v118
  v_permlane32_swap_b32 v117, v119
  v_permlane32_swap_b32 v120, v122
  v_permlane32_swap_b32 v121, v123
  v_permlane32_swap_b32 v124, v126
  v_permlane32_swap_b32 v125, v127
  v_permlane32_swap_b32 v128, v130
  v_permlane32_swap_b32 v129, v131
  v_permlane32_swap_b32 v132, v134
  v_permlane32_swap_b32 v133, v135
  v_permlane32_swap_b32 v136, v138
  v_permlane32_swap_b32 v137, v139
  v_permlane32_swap_b32 v140, v142
  v_permlane32_swap_b32 v141, v143
  v_mul_f32 v96, 0xbfb8aa3b, v116
  v_mul_f32 v97, 0xbfb8aa3b, v117
  v_mul_f32 v98, 0xbfb8aa3b, v120
  v_mul_f32 v99, 0xbfb8aa3b, v121
  v_mul_f32 v100, 0xbfb8aa3b, v124
  v_mul_f32 v101, 0xbfb8aa3b, v125
  v_mul_f32 v102, 0xbfb8aa3b, v128
  v_mul_f32 v103, 0xbfb8aa3b, v129
  v_mul_f32 v104, 0xbfb8aa3b, v132
  v_mul_f32 v105, 0xbfb8aa3b, v133
  v_mul_f32 v106, 0xbfb8aa3b, v136
  v_mul_f32 v107, 0xbfb8aa3b, v137
  v_mul_f32 v108, 0xbfb8aa3b, v140
  v_mul_f32 v109, 0xbfb8aa3b, v141
  v_exp_f32 v96, v96
  v_exp_f32 v97, v97
  v_exp_f32 v98, v98
  v_exp_f32 v99, v99
  v_exp_f32 v100, v100
  v_exp_f32 v101, v101
  v_exp_f32 v102, v102
  v_exp_f32 v103, v103
  v_exp_f32 v104, v104
  v_exp_f32 v105, v105
  v_exp_f32 v106, v106
  v_exp_f32 v107, v107
  v_exp_f32 v108, v108
  v_exp_f32 v109, v109
  v_add_f32 v96, 1.0, v96
  v_add_f32 v97, 1.0, v97
  v_add_f32 v98, 1.0, v98
  v_add_f32 v99, 1.0, v99
  v_add_f32 v100, 1.0, v100
  v_add_f32 v101, 1.0, v101
  v_add_f32 v102, 1.0, v102
  v_add_f32 v103, 1.0, v103
  v_add_f32 v104, 1.0, v104
  v_add_f32 v105, 1.0, v105
  v_add_f32 v106, 1.0, v106
  v_add_f32 v107, 1.0, v107
  v_add_f32 v108, 1.0, v108
  v_add_f32 v109, 1.0, v109
  v_rcp_f32 v96, v96
  v_rcp_f32 v97, v97
  v_rcp_f32 v98, v98
  v_rcp_f32 v99, v99
  v_rcp_f32 v100, v100
  v_rcp_f32 v101, v101
  v_rcp_f32 v102, v102
  v_rcp_f32 v103, v103
  v_rcp_f32 v104, v104
  v_rcp_f32 v105, v105
  v_rcp_f32 v106, v106
  v_rcp_f32 v107, v107
  v_rcp_f32 v108, v108
  v_rcp_f32 v109, v109
  v_mul_f32 v116, v116, v96
  v_mul_f32 v117, v117, v97
  v_mul_f32 v120, v120, v98
  v_mul_f32 v121, v121, v99
  v_mul_f32 v124, v124, v100
  v_mul_f32 v125, v125, v101
  v_mul_f32 v128, v128, v102
  v_mul_f32 v129, v129, v103
  v_mul_f32 v132, v132, v104
  v_mul_f32 v133, v133, v105
  v_mul_f32 v136, v136, v106
  v_mul_f32 v137, v137, v107
  v_mul_f32 v140, v140, v108
  v_mul_f32 v141, v141, v109
  v_cvt_pk_bf16_f32 v112, v116, v117
  v_lshlrev_b32 v116, 16, v112
  v_and_b32 v117, s62, v112
  v_cvt_pk_bf16_f32 v112, v120, v121
  v_lshlrev_b32 v120, 16, v112
  v_and_b32 v121, s62, v112
  v_cvt_pk_bf16_f32 v112, v124, v125
  v_lshlrev_b32 v124, 16, v112
  v_and_b32 v125, s62, v112
  v_cvt_pk_bf16_f32 v112, v128, v129
  v_lshlrev_b32 v128, 16, v112
  v_and_b32 v129, s62, v112
  v_cvt_pk_bf16_f32 v112, v132, v133
  v_lshlrev_b32 v132, 16, v112
  v_and_b32 v133, s62, v112
  v_cvt_pk_bf16_f32 v112, v136, v137
  v_lshlrev_b32 v136, 16, v112
  v_and_b32 v137, s62, v112
  v_cvt_pk_bf16_f32 v112, v140, v141
  v_lshlrev_b32 v140, 16, v112
  v_and_b32 v141, s62, v112
  v_mul_f32 v116, v116, v118
  v_mul_f32 v117, v117, v119
  v_mul_f32 v120, v120, v122
  v_mul_f32 v121, v121, v123
  v_mul_f32 v124, v124, v126
  v_mul_f32 v125, v125, v127
  v_mul_f32 v128, v128, v130
  v_mul_f32 v129, v129, v131
  v_mul_f32 v132, v132, v134
  v_mul_f32 v133, v133, v135
  v_mul_f32 v136, v136, v138
  v_mul_f32 v137, v137, v139
  v_mul_f32 v140, v140, v142
  v_mul_f32 v141, v141, v143
  v_cvt_pk_bf16_f32 v116, v116, v117
  ds_write_b32 v110, v116 offset:0
  v_cvt_pk_bf16_f32 v120, v120, v121
  ds_write_b32 v110, v120 offset:16
  v_cvt_pk_bf16_f32 v124, v124, v125
  ds_write_b32 v110, v124 offset:32
  v_cvt_pk_bf16_f32 v128, v128, v129
  ds_write_b32 v110, v128 offset:48
  v_cvt_pk_bf16_f32 v132, v132, v133
  ds_write_b32 v110, v132 offset:64
  v_cvt_pk_bf16_f32 v136, v136, v137
  ds_write_b32 v110, v136 offset:80
  v_cvt_pk_bf16_f32 v140, v140, v141
  ds_write_b32 v110, v140 offset:96
L_no_ffn_gather:
  s_waitcnt lgkmcnt(0)
  s_waitcnt vmcnt(0)
  s_barrier
  buffer_load_dwordx4 v[92:95], v60, s[48:51], s77 offen sc1
  ds_read_b128 v[16:19], v10 offset:0
  ds_read_b128 v[20:23], v10 offset:16384
  ds_read_b128 v[24:27], v10 offset:32768
  ds_read_b128 v[28:31], v10 offset:49152
  ds_read_b128 v[32:35], v11 offset:0
  ds_read_b128 v[36:39], v11 offset:16384
  ds_read_b128 v[40:43], v11 offset:32768
  ds_read_b128 v[44:47], v11 offset:49152
  s_waitcnt lgkmcnt(7)
  v_mul_f32 v80, v64, v16
  v_mul_f32 v81, v64, v17
  v_mul_f32 v82, v64, v18
  v_mul_f32 v83, v64, v19
  s_waitcnt lgkmcnt(6)
  v_mul_f32 v84, v65, v20
  v_mul_f32 v85, v65, v21
  v_mul_f32 v86, v65, v22
  v_mul_f32 v87, v65, v23
  s_waitcnt lgkmcnt(5)
  v_fmac_f32 v80, v66, v24
  v_fmac_f32 v81, v66, v25
  v_fmac_f32 v82, v66, v26
  v_fmac_f32 v83, v66, v27
  s_waitcnt lgkmcnt(4)
  v_fmac_f32 v84, v67, v28
  v_fmac_f32 v85, v67, v29
  v_fmac_f32 v86, v67, v30
  v_fmac_f32 v87, v67, v31
  s_waitcnt lgkmcnt(3)
  v_fmac_f32 v80, v68, v32
  v_fmac_f32 v81, v68, v33
  v_fmac_f32 v82, v68, v34
  v_fmac_f32 v83, v68, v35
  s_waitcnt lgkmcnt(2)
  v_fmac_f32 v84, v69, v36
  v_fmac_f32 v85, v69, v37
  v_fmac_f32 v86, v69, v38
  v_fmac_f32 v87, v69, v39
  s_waitcnt lgkmcnt(1)
  v_fmac_f32 v80, v70, v40
  v_fmac_f32 v81, v70, v41
  v_fmac_f32 v82, v70, v42
  v_fmac_f32 v83, v70, v43
  s_waitcnt lgkmcnt(0)
  v_fmac_f32 v84, v71, v44
  v_fmac_f32 v85, v71, v45
  v_fmac_f32 v86, v71, v46
  v_fmac_f32 v87, v71, v47
  v_add_f32 v80, v80, v84
  v_add_f32 v81, v81, v85
  v_add_f32 v82, v82, v86
  v_add_f32 v83, v83, v87
  v_cvt_pk_bf16_f32 v88, v80, v81
  v_cvt_pk_bf16_f32 v89, v82, v83
  s_mov_b32 exec_hi, 0
  buffer_store_dwordx4 v[88:91], v9, s[48:51], s68 offen
  buffer_store_dwordx4 v[88:91], v9, s[48:51], s63 offen sc1
  s_mov_b32 exec_hi, -1
  buffer_load_dwordx4 v[16:19], v14, s[48:51], s64 offen sc1
  buffer_load_dwordx4 v[20:23], v15, s[48:51], s64 offen sc1
  buffer_load_dwordx4 v[24:27], v62, s[48:51], s64 offen sc1
  buffer_load_dwordx4 v[28:31], v63, s[48:51], s64 offen sc1
  s_mov_b32 s72, 399998
  s_waitcnt vmcnt(6)
  v_cmp_ne_u64 s[56:57], s[58:59], v[94:95]
  v_mov_b32 v93, v92
  s_nop 1
  v_max_f32 v93, v93, v93 row_ror:1 row_mask:0xf bank_mask:0xf
  s_nop 1
  v_max_f32 v93, v93, v93 row_ror:2 row_mask:0xf bank_mask:0xf
  s_nop 1
  v_max_f32 v93, v93, v93 row_ror:4 row_mask:0xf bank_mask:0xf
  v_sub_f32 v92, v92, v93
  v_exp_f32 v92, v92
  s_nop 0
  v_mov_b32 v93, v92
  s_nop 1
  v_add_f32 v93, v93, v93 row_ror:1 row_mask:0xf bank_mask:0xf
  s_nop 1
  v_add_f32 v93, v93, v93 row_ror:2 row_mask:0xf bank_mask:0xf
  s_nop 1
  v_add_f32 v93, v93, v93 row_ror:4 row_mask:0xf bank_mask:0xf
  v_rcp_f32 v93, v93
  s_nop 0
  v_mul_f32 v92, v92, v93
  s_nop 1
  v_mov_b32 v40, v92 row_newbcast:0 row_mask:0x3 bank_mask:0xf
  s_nop 1
  v_mov_b32 v40, v92 row_newbcast:1 row_mask:0xc bank_mask:0xf
  v_mov_b32 v41, v92 row_newbcast:2 row_mask:0x3 bank_mask:0xf
  s_nop 1
  v_mov_b32 v41, v92 row_newbcast:3 row_mask:0xc bank_mask:0xf
  v_mov_b32 v42, v92 row_newbcast:4 row_mask:0x3 bank_mask:0xf
  s_nop 1
  v_mov_b32 v42, v92 row_newbcast:5 row_mask:0xc bank_mask:0xf
  v_mov_b32 v43, v92 row_newbcast:6 row_mask:0x3 bank_mask:0xf
  s_nop 1
  v_mov_b32 v43, v92 row_newbcast:7 row_mask:0xc bank_mask:0xf
  s_waitcnt vmcnt(0)
  v_cmp_ne_u64 vcc, s[58:59], v[18:19]
  v_cmp_ne_u64 s[70:71], s[58:59], v[22:23]
  v_cmp_ne_u64 s[74:75], s[58:59], v[26:27]
  v_cmp_ne_u64 s[78:79], s[58:59], v[30:31]
  s_or_b64 vcc, vcc, s[70:71]
  s_or_b64 s[74:75], s[74:75], s[78:79]
  s_or_b64 vcc, vcc, s[74:75]
  s_or_b64 vcc, vcc, s[56:57]
  s_cbranch_vccz L_poll3_out
L_poll3:
  s_and_b32 s73, s72, 7
  s_cselect_b32 s73, 0, 3342336
  s_add_u32 s76, s77, s73
  s_add_u32 s73, s64, s73
  buffer_load_dwordx4 v[92:95], v60, s[48:51], s76 offen sc1
  buffer_load_dwordx4 v[16:19], v14, s[48:51], s73 offen sc1
  buffer_load_dwordx4 v[20:23], v15, s[48:51], s73 offen sc1
  buffer_load_dwordx4 v[24:27], v62, s[48:51], s73 offen sc1
  buffer_load_dwordx4 v[28:31], v63, s[48:51], s73 offen sc1
  s_waitcnt vmcnt(4)
  v_cmp_ne_u64 s[56:57], s[58:59], v[94:95]
  v_mov_b32 v93, v92
  s_nop 1
  v_max_f32 v93, v93, v93 row_ror:1 row_mask:0xf bank_mask:0xf
  s_nop 1
  v_max_f32 v93, v93, v93 row_ror:2 row_mask:0xf bank_mask:0xf
  s_nop 1
  v_max_f32 v93, v93, v93 row_ror:4 row_mask:0xf bank_mask:0xf
  v_sub_f32 v92, v92, v93
  v_exp_f32 v92, v92
  s_nop 0
  v_mov_b32 v93, v92
  s_nop 1
  v_add_f32 v93, v93, v93 row_ror:1 row_mask:0xf bank_mask:0xf
  s_nop 1
  v_add_f32 v93, v93, v93 row_ror:2 row_mask:0xf bank_mask:0xf
  s_nop 1
  v_add_f32 v93, v93, v93 row_ror:4 row_mask:0xf bank_mask:0xf
  v_rcp_f32 v93, v93
  s_nop 0
  v_mul_f32 v92, v92, v93
  s_nop 1
  v_mov_b32 v40, v92 row_newbcast:0 row_mask:0x3 bank_mask:0xf
  s_nop 1
  v_mov_b32 v40, v92 row_newbcast:1 row_mask:0xc bank_mask:0xf
  v_mov_b32 v41, v92 row_newbcast:2 row_mask:0x3 bank_mask:0xf
  s_nop 1
  v_mov_b32 v41, v92 row_newbcast:3 row_mask:0xc bank_mask:0xf
  v_mov_b32 v42, v92 row_newbcast:4 row_mask:0x3 bank_mask:0xf
  s_nop 1
  v_mov_b32 v42, v92 row_newbcast:5 row_mask:0xc bank_mask:0xf
  v_mov_b32 v43, v92 row_newbcast:6 row_mask:0x3 bank_mask:0xf
  s_nop 1
  v_mov_b32 v43, v92 row_newbcast:7 row_mask:0xc bank_mask:0xf
  s_waitcnt vmcnt(0)
  v_cmp_ne_u64 vcc, s[58:59], v[18:19]
  v_cmp_ne_u64 s[70:71], s[58:59], v[22:23]
  v_cmp_ne_u64 s[74:75], s[58:59], v[26:27]
  v_cmp_ne_u64 s[78:79], s[58:59], v[30:31]
  s_or_b64 vcc, vcc, s[70:71]
  s_or_b64 s[74:75], s[74:75], s[78:79]
  s_or_b64 vcc, vcc, s[74:75]
  s_or_b64 vcc, vcc, s[56:57]
  s_sub_u32 s72, s72, 1
  s_cbranch_scc1 L_poll3_out
  s_cbranch_vccnz L_poll3
L_poll3_out:
  v_lshlrev_b32 v64, 16, v16
  v_and_b32 v65, s62, v16
  v_lshlrev_b32 v66, 16, v17
  v_and_b32 v67, s62, v17
  v_lshlrev_b32 v68, 16, v20
  v_and_b32 v69, s62, v20
  v_lshlrev_b32 v70, 16, v21
  v_and_b32 v71, s62, v21
  v_lshlrev_b32 v72, 16, v24
  v_and_b32 v73, s62, v24
  v_lshlrev_b32 v74, 16, v25
  v_and_b32 v75, s62, v25
  v_lshlrev_b32 v76, 16, v28
  v_and_b32 v77, s62, v28
  v_lshlrev_b32 v78, 16, v29
  v_and_b32 v79, s62, v29
  v_mul_f32 v32, v40, v64
  v_mul_f32 v36, v41, v68
  v_mul_f32 v33, v40, v65
  v_mul_f32 v37, v41, v69
  v_mul_f32 v34, v40, v66
  v_mul_f32 v38, v41, v70
  v_mul_f32 v35, v40, v67
  v_mul_f32 v39, v41, v71
  v_fmac_f32 v32, v42, v72
  v_fmac_f32 v36, v43, v76
  v_fmac_f32 v33, v42, v73
  v_fmac_f32 v37, v43, v77
  v_fmac_f32 v34, v42, v74
  v_fmac_f32 v38, v43, v78
  v_fmac_f32 v35, v42, v75
  v_fmac_f32 v39, v43, v79
  v_add_f32 v32, v32, v36
  v_add_f32 v33, v33, v37
  v_add_f32 v34, v34, v38
  v_add_f32 v35, v35, v39
  v_mov_b32 v36, v32
  v_mov_b32 v37, v33
  v_mov_b32 v38, v34
  v_mov_b32 v39, v35
  v_permlane32_swap_b32 v32, v36
  v_permlane32_swap_b32 v33, v37
  v_permlane32_swap_b32 v34, v38
  v_permlane32_swap_b32 v35, v39
  v_add_f32 v32, v32, v36
  v_add_f32 v33, v33, v37
  v_add_f32 v34, v34, v38
  v_add_f32 v35, v35, v39
  v_cvt_pk_bf16_f32 v30, v32, v33
  v_cvt_pk_bf16_f32 v31, v34, v35
  ds_write_b64 v54, v[30:31]
  s_waitcnt lgkmcnt(0)
  s_barrier
  s_cmp_eq_u32 s3, 1
  s_cbranch_scc0 L_no_notify
  s_mov_b64 exec, 3
  buffer_store_dwordx2 v[90:91], v52, s[48:51], s65 offen sc1
L_no_notify:
  s_cmp_ge_u32 s2, 64
  s_cbranch_scc1 L_svc_end
  s_cmp_eq_u32 s3, 0
  s_cbranch_scc0 L_svc_end
  s_mov_b32 s72, 400000
  s_mov_b64 exec, 0xff
L_fin_loop:
  v_mov_b32 v48, 0
  v_mov_b32 v49, 0
  buffer_atomic_add_x2 v[48:49], v58, s[48:51], s66 offen sc0 sc1
  s_waitcnt vmcnt(0)
  s_sub_u32 s72, s72, 1
  s_cbranch_scc1 L_fin_go
  v_cmp_ne_u64 vcc, s[58:59], v[48:49]
  s_cbranch_vccnz L_fin_loop
L_fin_go:
  s_mov_b64 exec, -1
L_poll4:
  buffer_load_dwordx4 v[16:19], v53, s[48:51], s67 offen offset:0 sc1
  buffer_load_dwordx4 v[20:23], v53, s[48:51], s67 offen offset:1024 sc1
  buffer_load_dwordx4 v[24:27], v53, s[48:51], s67 offen offset:2048 sc1
  buffer_load_dwordx4 v[28:31], v53, s[48:51], s67 offen offset:3072 sc1
  s_waitcnt vmcnt(0)
  v_cmp_ne_u64 vcc, s[58:59], v[18:19]
  v_cmp_ne_u64 s[70:71], s[58:59], v[22:23]
  v_cmp_ne_u64 s[74:75], s[58:59], v[26:27]
  v_cmp_ne_u64 s[78:79], s[58:59], v[30:31]
  s_sub_u32 s72, s72, 1
  s_cbranch_scc1 L_poll4_out
  s_or_b64 vcc, vcc, s[70:71]
  s_or_b64 s[74:75], s[74:75], s[78:79]
  s_or_b64 vcc, vcc, s[74:75]
  s_cbranch_vccnz L_poll4
L_poll4_out:
  v_lshlrev_b32 v64, 16, v16
  v_and_b32 v65, s62, v16
  v_lshlrev_b32 v66, 16, v17
  v_and_b32 v67, s62, v17
  v_lshlrev_b32 v68, 16, v20
  v_and_b32 v69, s62, v20
  v_lshlrev_b32 v70, 16, v21
  v_and_b32 v71, s62, v21
  v_lshlrev_b32 v72, 16, v24
  v_and_b32 v73, s62, v24
  v_lshlrev_b32 v74, 16, v25
  v_and_b32 v75, s62, v25
  v_lshlrev_b32 v76, 16, v28
  v_and_b32 v77, s62, v28
  v_lshlrev_b32 v78, 16, v29
  v_and_b32 v79, s62, v29
  v_add_f32 v64, v64, v68
  v_add_f32 v72, v72, v76
  v_add_f32 v65, v65, v69
  v_add_f32 v73, v73, v77
  v_add_f32 v66, v66, v70
  v_add_f32 v74, v74, v78
  v_add_f32 v67, v67, v71
  v_add_f32 v75, v75, v79
  v_add_f32 v32, v64, v72
  v_add_f32 v33, v65, v73
  v_add_f32 v34, v66, v74
  v_add_f32 v35, v67, v75
  v_add_f32 v32, v32, v32 row_ror:8 row_mask:0xf bank_mask:0xf
  v_add_f32 v33, v33, v33 row_ror:8 row_mask:0xf bank_mask:0xf
  v_add_f32 v34, v34, v34 row_ror:8 row_mask:0xf bank_mask:0xf
  v_add_f32 v35, v35, v35 row_ror:8 row_mask:0xf bank_mask:0xf
  v_mov_b32 v36, v32
  v_mov_b32 v37, v33
  v_mov_b32 v38, v34
  v_mov_b32 v39, v35
  v_permlane32_swap_b32 v32, v36
  v_permlane32_swap_b32 v33, v37
  v_permlane32_swap_b32 v34, v38
  v_permlane32_swap_b32 v35, v39
  v_add_f32 v32, v32, v36
  v_add_f32 v33, v33, v37
  v_add_f32 v34, v34, v38
  v_add_f32 v35, v35, v39
  v_mov_b32 v36, v32
  v_mov_b32 v37, v33
  v_mov_b32 v38, v34
  v_mov_b32 v39, v35
  v_permlane16_swap_b32 v32, v36
  v_permlane16_swap_b32 v33, v37
  v_permlane16_swap_b32 v34, v38
  v_permlane16_swap_b32 v35, v39
  v_add_f32 v32, v32, v36
  v_add_f32 v33, v33, v37
  v_add_f32 v34, v34, v38
  v_add_f32 v35, v35, v39
  v_lshlrev_b32 v36, 16, v56
  v_and_b32 v37, s62, v56
  v_lshlrev_b32 v38, 16, v57
  v_and_b32 v39, s62, v57
  v_add_f32 v32, v32, v36
  v_add_f32 v33, v33, v37
  v_add_f32 v34, v34, v38
  v_add_f32 v35, v35, v39
  v_cvt_pk_bf16_f32 v16, v32, v33
  v_cvt_pk_bf16_f32 v17, v34, v35
  s_mov_b64 exec, 0xff
  buffer_store_dwordx2 v[16:17], v61, s[52:55], s11 offen
  s_cmp_eq_u32 s2, 0
  s_cbranch_scc0 L_no_epoch
  s_mov_b64 exec, 1
  v_mov_b32 v8, 0
  buffer_store_dwordx2 v[90:91], v8, s[48:51], 0 offen sc1
L_no_epoch:
L_svc_end:
  s_endpgm
.section .rodata,"a"
.p2align 6
.amdhsa_kernel parallel_sum__gqa_block_cached__glu_gated_swiglu__decode_kernel
  .amdhsa_next_free_vgpr 168
  .amdhsa_next_free_sgpr 102
  .amdhsa_accum_offset 168
  .amdhsa_group_segment_fixed_size 0
  .amdhsa_kernarg_size 96
  .amdhsa_user_sgpr_count 2
  .amdhsa_user_sgpr_kernarg_segment_ptr 1
  .amdhsa_system_sgpr_workgroup_id_x 1
.end_amdhsa_kernel
```
